```python
import torch

def _softmax(x, axis=-1):
    return torch.softmax(x, dim=axis)
def _gelu(x):
    return torch.nn.functional.gelu(x, approximate="tanh")
def _silu(x):
    return torch.nn.functional.silu(x)
def _sigmoid(x):
    return torch.sigmoid(x)
def _layernorm(x, axis=-1, eps=1e-5):
    m = x.mean(dim=axis, keepdim=True)
    v = x.var(dim=axis, keepdim=True, unbiased=False)
    return (x - m) / torch.sqrt(v + eps)
def _scatter_add(tgt, idx, src, axis=0):
    return tgt.clone().index_add_(axis, idx, src)
def _segment_sum(src, seg, n):
    out = torch.zeros((n,) + src.shape[1:], dtype=src.dtype)
    return out.index_add_(0, seg, src)
def _pad(x, pw):
    flat = tuple(v for pair in reversed(pw) for v in pair)
    return torch.nn.functional.pad(x, flat)

kernel_name = 'recurrent_scan__ssm_conv_s4__dense_activation_mish__prompt'

def setup_inputs():

    _w = (lambda a: (lambda t: t.to(torch.bfloat16) if t.is_floating_point() else t)(torch.as_tensor(a)))
    def _A_setup():
        B, L, D, N = 1, 2048, 448, 256
        A_re = -(lambda _x: torch.exp(torch.as_tensor(_x)))((lambda *s: torch.randn(*s, dtype=torch.bfloat16) * 3.2)(D, N))
        A_im = torch.pi * (lambda *s: torch.randn(*s, dtype=torch.bfloat16) * 0.2)(D, N)
        B_re = (lambda *s: torch.randn(*s, dtype=torch.bfloat16) * 0.2)(D, N)
        B_im = (lambda *s: torch.randn(*s, dtype=torch.bfloat16) * 0.2)(D, N)
        C_re = (lambda *s: torch.randn(*s, dtype=torch.bfloat16) * 0.2)(D, N)
        C_im = (lambda *s: torch.randn(*s, dtype=torch.bfloat16) * 0.2)(D, N)
        log_dt = (lambda *s: torch.randn(*s, dtype=torch.bfloat16) * 0.2)(D) * 0.5 - 4.0
        Dskip = (lambda *s: torch.randn(*s, dtype=torch.bfloat16) * 0.2)(D)
        return {
            "u": _w((lambda *s: torch.randn(*s, dtype=torch.bfloat16) * 0.05)(B, L, D)),
            "A_re": _w(A_re),
            "A_im": _w(A_im),
            "B_re": _w(B_re),
            "B_im": _w(B_im),
            "C_re": _w(C_re),
            "C_im": _w(C_im),
            "log_dt": _w(log_dt),
            "Dskip": _w(Dskip),
        }
    _A_in = _A_setup()

    def _B_setup():
        B, S, D, F = 1, 2048, 448, 1792
        return {
            "x": _w((lambda *s: torch.randn(*s, dtype=torch.bfloat16) * 0.05)(B, S, D)),
            "w1": _w((lambda *s: torch.randn(*s, dtype=torch.bfloat16) * 0.8)(D, F) * (D ** -0.5)),
            "b1": _w((lambda *s: torch.randn(*s, dtype=torch.bfloat16) * 0.1)(F)),
            "w2": _w((lambda *s: torch.randn(*s, dtype=torch.bfloat16) * 0.1)(F, D) * (F ** -0.5)),
        }
    _B_in = _B_setup()

    return {
        "A_u": _A_in["u"],
        "A_A_re": _A_in["A_re"],
        "A_A_im": _A_in["A_im"],
        "A_B_re": _A_in["B_re"],
        "A_B_im": _A_in["B_im"],
        "A_C_re": _A_in["C_re"],
        "A_C_im": _A_in["C_im"],
        "A_log_dt": _A_in["log_dt"],
        "A_Dskip": _A_in["Dskip"],
        "B_x": _B_in["x"],
        "B_w1": _B_in["w1"],
        "B_b1": _B_in["b1"],
        "B_w2": _B_in["w2"],
    }

def reference(A_u, A_A_re, A_A_im, A_B_re, A_B_im, A_C_re, A_C_im, A_log_dt, A_Dskip, B_x, B_w1, B_b1, B_w2):
    def _A_ref(u, A_re, A_im, B_re, B_im, C_re, C_im, log_dt, Dskip):
        Bsz, L, D = u.shape
        dt = torch.exp(log_dt)[:, None]
        A = A_re + 1j * A_im
        Bc = B_re + 1j * B_im
        Cc = C_re + 1j * C_im
        logdA = dt * A
        dB = dt * Bc
        l = (lambda x, dt: x.to(dt))(torch.arange(L), A_re.dtype)
        P = torch.exp(logdA[:, :, None] * l[None, None, :])
        K = torch.einsum("dn,dnl,dn->dl", Cc, P, dB).real
        L2 = 2 * L
        Kp = _pad(K, ((0, 0), (0, L)))
        up = (lambda x, *d: x.permute(*d))(u, 0, 2, 1)
        up = _pad(up, ((0, 0), (0, 0), (0, L)))
        Kf = (lambda x, axes=(-2,-1): torch.fft.rfft2(x.float(), dim=axes))(Kp[:, None, :], axes=(-2, -1))
        Uf = (lambda x, axes=(-2,-1): torch.fft.rfft2(x.float(), dim=axes))(up[:, :, None, :], axes=(-2, -1))
        Yf = Uf * Kf[None, :, :, :]
        y = (lambda x, s, axes=(-2,-1): torch.fft.irfft2(x, s=s, dim=axes).to(torch.bfloat16))(Yf, (1, L2), axes=(-2, -1))[:, :, 0, :L]
        y = (lambda x, *d: x.permute(*d))(y, 0, 2, 1) + u * Dskip[None, None, :]
        return y

    def _B_ref(x, w1, b1, w2):
        h = torch.einsum("bsd,df->bsf", x, w1) + b1
        sp = torch.log1p(torch.exp(-torch.abs(h))) + torch.where(h > 0, h, torch.zeros_like(h))
        act = h * torch.tanh(sp)
        return torch.einsum("bsf,fd->bsd", act, w2)

    x = A_u
    xn = _layernorm(x, axis=-1)
    s = _A_ref(xn, A_A_re, A_A_im, A_B_re, A_B_im, A_C_re, A_C_im, A_log_dt, A_Dskip)
    g = _silu(_B_ref(xn, B_w1, B_b1, B_w2))
    return x + s * g
```

```asm
; @launch grid=(256,1,1) block=(512,1,1) lds=163840
.amdgcn_target "amdgcn-amd-amdhsa--gfx950"
.text
.p2align 12
.fill 832, 4, 0xbf800000
.globl recurrent_scan__ssm_conv_s4__dense_activation_mish__prompt_kernel
.p2align 8
.type recurrent_scan__ssm_conv_s4__dense_activation_mish__prompt_kernel,@function
recurrent_scan__ssm_conv_s4__dense_activation_mish__prompt_kernel:
    s_load_dwordx16 s[28:43], s[0:1], 0
    s_load_dwordx16 s[44:59], s[0:1], 64
    s_cmpk_ge_u32 s2, 256
    s_cbranch_scc1 L_end
    s_lshr_b32 s61, s2, 3
    s_getpc_b64 s[72:73]
L_pc_1:
    v_and_b32 v2, 15, v0
    v_lshl_add_u32 v2, s61, 4, v2
    v_min_u32 v2, (L_tab+4032-L_pc_1)/64, v2
    v_mov_b32 v3, 0
    v_lshlrev_b32 v2, 6, v2
    v_lshl_add_u64 v[2:3], v[2:3], 0, s[72:73]
    global_load_dword v99, v[2:3], off
    s_sub_u32 s67, s2, 32
    s_cbranch_scc1 L_helper
    v_and_b32 v1, 0xff, v0
    v_lshl_add_u32 v1, s67, 8, v1
    v_lshlrev_b32 v1, 2, v1
    s_lshl_b32 s73, s67, 2
    v_xor_b32 v3, 0x1000, v1
    v_lshrrev_b32 v2, 6, v0
    v_and_b32 v0, 63, v0
    v_readfirstlane_b32 s3, v2
    s_and_b32 s60, s2, 7
    s_sub_u32 s61, s61, 4
    s_mul_i32 s62, s61, 37
    s_lshr_b32 s62, s62, 8
    s_mul_i32 s63, s62, 7
    s_sub_u32 s63, s61, s63
    s_lshr_b32 s64, s60, 1
    s_lshl2_add_u32 s64, s64, s62
    s_and_b32 s61, s60, 1
    s_mul_i32 s65, s61, 7
    s_add_u32 s65, s65, s63
    s_lshl1_add_u32 s66, s62, s63
    s_sub_u32 s71, s66, 7
    s_cselect_b32 s66, s66, s71
    s_bfe_u32 s68, s3, 0x10001
    s_and_b32 s69, s3, 3
    s_lshl_b32 s70, s69, 12
    s_add_u32 s70, s70, 49152
    s_waitcnt lgkmcnt(0)
    global_load_dword v100, v1, s[30:31]
    global_load_dword v101, v1, s[32:33]
    s_load_dword s74, s[42:43], s73
    s_load_dword s75, s[44:45], s73
    v_lshrrev_b32 v154, 3, v0
    v_and_b32 v155, 7, v0
    v_lshrrev_b32 v156, 4, v0
    v_xor_b32 v155, v155, v156
    v_lshl_add_u32 v154, s69, 5, v154
    v_mul_u32_u24 v154, 896, v154
    v_lshl_add_u32 v150, v155, 4, v154
    v_xor_b32 v155, 64, v150
    v_add_u32 v151, 6144, v155
    v_add_u32 v152, 12288, v150
    v_add_u32 v153, 18432, v155
    v_lshrrev_b32 v154, 4, v0
    v_and_b32 v155, 15, v0
    v_lshlrev_b32 v156, 1, v154
    v_xor_b32 v155, v155, v156
    v_lshl_add_u32 v154, s69, 4, v154
    v_mul_u32_u24 v154, 3584, v154
    v_lshl_add_u32 v132, v155, 4, v154
    v_xor_b32 v155, 0x80, v132
    v_add_u32 v133, 13312, v132
    v_add_u32 v134, 26624, v155
    v_add_u32 v135, 39936, v155
    global_load_dword v99, v3, s[30:31]
    global_load_dword v99, v3, s[32:33]
    global_load_dword v102, v1, s[34:35] nt
    global_load_dword v103, v1, s[36:37] nt
    global_load_dword v104, v1, s[38:39] nt
    global_load_dword v105, v1, s[40:41] nt
    s_mov_b64 s[4:5], s[28:29]
    s_mov_b64 s[8:9], s[48:49]
    s_mov_b32 s6, 1835008
    s_mov_b32 s7, 0x20000
    s_mov_b32 s10, 1605632
    s_mov_b32 s11, 0x20000
    s_mul_i32 s76, s64, 114688
    s_lshl_b32 s71, s66, 7
    s_add_u32 s76, s76, s71
    s_mul_i32 s77, s66, 229376
    s_lshl_b32 s71, s65, 8
    s_add_u32 s77, s77, s71
    s_xor_b32 s46, s3, 4
    s_mul_i32 s46, s46, 8704
    s_mov_b32 s47, 0x03020c0c
    s_cmp_lt_u32 s3, 4
    s_cselect_b32 s47, 0x01000c0c, s47
    s_cselect_b32 s1, 0, 1
    s_mov_b32 m0, s46
    s_add_u32 s71, s46, 14336
    v_and_b32 v154, 31, v0
    v_lshrrev_b32 v155, 5, v0
    v_mul_u32_u24 v156, 272, v154
    v_lshl_add_u32 v156, v155, 4, v156
    v_add_u32 v140, s71, v156
    s_mov_b32 s44, 0x41000000
    s_mov_b32 s45, 0x43800000
    v_mov_b32 v128, 0x3f80
    ds_write_addtid_b32 v128 offset:14336
    s_mul_i32 s39, s68, 6864
    s_and_b32 s40, s3, 1
    s_mul_i32 s71, s40, 3328
    s_add_u32 s39, s39, s71
    s_add_u32 s39, s39, 84480
    v_lshl_add_u32 v141, v0, 4, s39
    s_mov_b64 s[16:17], s[58:59]
    s_mov_b32 s18, 33554432
    s_mov_b32 s19, 0x20000
    s_lshl1_add_u32 s41, s66, s61
    v_mov_b32 v30, 0
    v_mov_b32 v31, 0
    v_mov_b32 v32, 0
    v_mov_b32 v33, 0
    s_cmp_eq_u32 s1, 1
    s_cbranch_scc1 L_g0_2
    v_lshrrev_b32 v14, 5, v0
    v_and_b32 v15, 31, v0
    s_lshl_b32 s71, s40, 13
    s_add_u32 s71, s71, 65536
    v_bfe_u32 v13, v0, 1, 3
    v_lshrrev_b32 v50, 4, v0
    v_xor_b32 v12, v13, v50
    v_lshlrev_b32 v12, 4, v12
    v_and_b32 v11, 15, v0
    v_lshl_add_u32 v12, v11, 7, v12
    v_add_u32 v80, s71, v12
    v_xor_b32 v81, 64, v80
    v_and_b32 v54, 1, v0
    v_lshlrev_b32 v53, 13, v13
    v_lshl_add_u32 v53, v50, 4, v53
    v_lshl_add_u32 v46, v54, 6, v53
    v_bfe_u32 v10, v0, 2, 2
    v_and_b32 v11, 3, v0
    v_lshlrev_b32 v11, 3, v11
    v_bfe_u32 v12, v0, 2, 3
    s_lshl_b32 s71, s68, 2
    v_xor_b32 v12, s71, v12
    v_lshl_add_u32 v12, v12, 5, v11
    v_lshl_add_u32 v13, v50, 3, v10
    v_lshl_add_u32 v12, v13, 8, v12
    v_add_u32 v82, 131072, v12
    v_xor_b32 v83, 32, v82
    v_xor_b32 v84, 64, v82
    v_xor_b32 v85, 96, v82
    s_lshl_b32 s71, s61, 2
    v_lshl_add_u32 v52, v50, 3, v10
    v_bfe_u32 v53, v0, 1, 1
    v_or_b32 v53, s71, v53
    v_bfe_u32 v51, v52, 1, 3
    v_xor_b32 v53, v53, v51
    v_lshlrev_b32 v53, 4, v53
    s_add_u32 s71, s70, 49152
    v_lshl_add_u32 v53, v52, 7, v53
    v_lshl_add_u32 v53, v54, 3, v53
    v_add_u32 v44, s71, v53
    v_xor_b32 v45, 32, v44
    s_lshl_b32 s71, s41, 8
    s_add_u32 s71, s71, s64
    s_lshl2_add_u32 s71, s71, s69
    s_lshl_b32 s71, s71, 7
    s_add_u32 s37, s71, 1048576
    s_add_u32 s38, s37, 65536
    s_mul_i32 s71, s3, 4576
    s_cmp_ge_u32 s3, 2
    s_cselect_b32 s71, 13312, s71
    s_sub_u32 s72, s39, 16
    v_min_u32 v156, 29, v0
    v_lshl_add_u32 v156, v156, 4, s71
    v_mov_b32 v155, s72
    v_cmp_eq_u32 vcc, 0, v14
    s_nop 1
    v_cndmask_b32 v156, v155, v156, vcc
    ds_write_b128 v156, v[30:33]
    s_branch L_g1_3
L_g0_2:
    s_getpc_b64 s[72:73]
L_tb_4:
    v_lshl_add_u32 v2, s40, 7, v0
    v_lshlrev_b32 v2, 4, v2
    v_add_u32 v2, L_tab-L_tb_4, v2
    v_mov_b32 v3, 0
    v_lshl_add_u64 v[76:77], v[2:3], 0, s[72:73]
    s_mov_b64 s[12:13], s[52:53]
    s_mov_b32 s14, 1605632
    s_mov_b32 s15, 0x20000
    s_mov_b64 s[24:25], s[54:55]
    s_mov_b32 s26, 1835008
    s_mov_b32 s27, 0x20000
    s_xor_b32 s71, s3, s60
    s_bitcmp1_b32 s71, 0
    s_cselect_b32 s43, 0, s63
    s_and_b32 s71, s3, 1
    s_mul_i32 s71, s71, 14
    s_add_u32 s71, s71, s68
    s_mul_i32 s32, s71, 57344
    s_lshl_b32 s71, s66, 7
    s_add_u32 s32, s32, s71
    s_add_u32 s33, s32, 114688
    s_mul_i32 s42, s43, 114688
    s_add_u32 s42, s42, s32
L_g1_3:
    v_mov_b32 v154, 0x3fb8aa3b
    v_mov_b32 v149, 0x32a57060
    s_lshl_b32 s71, s68, 4
    s_waitcnt lgkmcnt(0)
    s_lshr_b32 s74, s74, s71
    s_lshl_b32 s74, s74, 16
    v_mul_f32 v155, s74, v154
    v_fma_f32 v156, s74, v154, -v155
    v_fmac_f32 v156, s74, v149
    v_exp_f32 v155, v155
    v_mul_f32 v156, 0x3f317218, v156
    v_fmac_f32 v155, v155, v156
    v_cvt_pk_bf16_f32 v155, v155, v155
    v_and_b32 v148, 0xffff0000, v155
    v_mul_f32 v146, v154, v148
    v_mul_f32 v147, 0.15915494, v148
    s_waitcnt vmcnt(6)
    s_cmp_eq_u32 s1, 1
    s_cbranch_scc1 L_c0_5
    s_add_u32 m0, s70, 49152
    s_nop 0
    buffer_load_dwordx4 v150, s[4:7], s76 offen offset:0 lds
    buffer_load_dwordx4 v151, s[4:7], s76 offen offset:1024 lds
    buffer_load_dwordx4 v152, s[4:7], s76 offen offset:2048 lds
    buffer_load_dwordx4 v153, s[4:7], s76 offen offset:3072 lds
L_c0_5:
    s_mov_b32 m0, s46
    v_perm_b32 v100, v100, v100, s47
    v_perm_b32 v101, v101, v101, s47
    v_pk_mul_f32 v[106:107], v[100:101], v[146:147]
    v_pk_mul_f32 v[108:109], v[106:107], s[44:45] op_sel_hi:[1,0]
    v_pk_mul_f32 v[110:111], v[106:107], s[44:45] op_sel:[0,1] op_sel_hi:[1,1]
    v_fract_f32 v109, v109
    v_fract_f32 v107, v107
    v_fract_f32 v111, v111
    v_exp_f32 v108, v108
    v_cos_f32 v114, v109
    v_sin_f32 v115, v109
    v_exp_f32 v106, v106
    v_cos_f32 v112, v107
    v_sin_f32 v113, v107
    v_exp_f32 v110, v110
    v_cos_f32 v116, v111
    v_sin_f32 v117, v111
    v_pk_mul_f32 v[114:115], v[114:115], v[108:109] op_sel_hi:[1,0]
    v_pk_mul_f32 v[112:113], v[112:113], v[106:107] op_sel_hi:[1,0]
    v_pk_mul_f32 v[116:117], v[116:117], v[110:111] op_sel_hi:[1,0]
    v_cvt_pk_bf16_f32 v129, v114, v115
    ds_write_addtid_b32 v129 offset:14608
    s_cmp_eq_u32 s1, 0
    s_cbranch_scc1 L_kp_6
    s_setprio 1
L_kp_6:
    v_pk_mul_f32 v[122:123], v[114:115], v[114:115] op_sel_hi:[1,0]
    v_pk_fma_f32 v[124:125], v[114:115], v[114:115], v[122:123] op_sel:[1,1,0] op_sel_hi:[0,1,1] neg_lo:[0,1,0]
    v_cvt_pk_bf16_f32 v130, v124, v125
    ds_write_addtid_b32 v130 offset:14880
    v_pk_mul_f32 v[122:123], v[124:125], v[114:115] op_sel_hi:[1,0]
    v_pk_fma_f32 v[124:125], v[124:125], v[114:115], v[122:123] op_sel:[1,1,0] op_sel_hi:[0,1,1] neg_lo:[0,1,0]
    v_cvt_pk_bf16_f32 v131, v124, v125
    ds_write_addtid_b32 v131 offset:15152
    v_pk_mul_f32 v[122:123], v[124:125], v[114:115] op_sel_hi:[1,0]
    v_pk_fma_f32 v[124:125], v[124:125], v[114:115], v[122:123] op_sel:[1,1,0] op_sel_hi:[0,1,1] neg_lo:[0,1,0]
    v_cvt_pk_bf16_f32 v128, v124, v125
    ds_write_addtid_b32 v128 offset:15424
    v_pk_mul_f32 v[122:123], v[124:125], v[114:115] op_sel_hi:[1,0]
    v_pk_fma_f32 v[124:125], v[124:125], v[114:115], v[122:123] op_sel:[1,1,0] op_sel_hi:[0,1,1] neg_lo:[0,1,0]
    v_cvt_pk_bf16_f32 v129, v124, v125
    ds_write_addtid_b32 v129 offset:15696
    v_pk_mul_f32 v[122:123], v[124:125], v[114:115] op_sel_hi:[1,0]
    v_pk_fma_f32 v[124:125], v[124:125], v[114:115], v[122:123] op_sel:[1,1,0] op_sel_hi:[0,1,1] neg_lo:[0,1,0]
    v_cvt_pk_bf16_f32 v130, v124, v125
    ds_write_addtid_b32 v130 offset:15968
    s_cmp_eq_u32 s1, 1
    s_cbranch_scc1 L_c0_7
    s_add_u32 m0, s70, 81920
    s_nop 0
    buffer_load_dwordx4 v132, s[8:11], s77 offen offset:0 lds
    buffer_load_dwordx4 v133, s[8:11], s77 offen offset:1024 lds
    buffer_load_dwordx4 v134, s[8:11], s77 offen offset:2048 lds
    buffer_load_dwordx4 v135, s[8:11], s77 offen offset:3072 lds
L_c0_7:
    s_mov_b32 m0, s46
    s_add_u32 s76, s76, 128
    s_add_u32 s77, s77, 229376
    s_cmp_ge_u32 s77, 1605632
    s_cselect_b32 s34, 896, 0
    s_cselect_b32 s35, 1605632, 0
    s_sub_u32 s76, s76, s34
    s_sub_u32 s77, s77, s35
    v_pk_mul_f32 v[122:123], v[124:125], v[114:115] op_sel_hi:[1,0]
    v_pk_fma_f32 v[124:125], v[124:125], v[114:115], v[122:123] op_sel:[1,1,0] op_sel_hi:[0,1,1] neg_lo:[0,1,0]
    v_cvt_pk_bf16_f32 v131, v124, v125
    ds_write_addtid_b32 v131 offset:16240
    v_pk_mul_f32 v[122:123], v[124:125], v[114:115] op_sel_hi:[1,0]
    v_pk_fma_f32 v[124:125], v[124:125], v[114:115], v[122:123] op_sel:[1,1,0] op_sel_hi:[0,1,1] neg_lo:[0,1,0]
    v_cvt_pk_bf16_f32 v128, v124, v125
    ds_write_addtid_b32 v128 offset:16512
    v_pk_mul_f32 v[122:123], v[124:125], v[114:115] op_sel_hi:[1,0]
    v_pk_fma_f32 v[124:125], v[124:125], v[114:115], v[122:123] op_sel:[1,1,0] op_sel_hi:[0,1,1] neg_lo:[0,1,0]
    v_cvt_pk_bf16_f32 v129, v124, v125
    ds_write_addtid_b32 v129 offset:16784
    v_pk_mul_f32 v[122:123], v[124:125], v[114:115] op_sel_hi:[1,0]
    v_pk_fma_f32 v[124:125], v[124:125], v[114:115], v[122:123] op_sel:[1,1,0] op_sel_hi:[0,1,1] neg_lo:[0,1,0]
    v_cvt_pk_bf16_f32 v130, v124, v125
    ds_write_addtid_b32 v130 offset:17056
    v_pk_mul_f32 v[122:123], v[124:125], v[114:115] op_sel_hi:[1,0]
    v_pk_fma_f32 v[124:125], v[124:125], v[114:115], v[122:123] op_sel:[1,1,0] op_sel_hi:[0,1,1] neg_lo:[0,1,0]
    v_cvt_pk_bf16_f32 v131, v124, v125
    ds_write_addtid_b32 v131 offset:17328
    v_pk_mul_f32 v[122:123], v[124:125], v[114:115] op_sel_hi:[1,0]
    v_pk_fma_f32 v[124:125], v[124:125], v[114:115], v[122:123] op_sel:[1,1,0] op_sel_hi:[0,1,1] neg_lo:[0,1,0]
    v_cvt_pk_bf16_f32 v128, v124, v125
    ds_write_addtid_b32 v128 offset:17600
    v_pk_mul_f32 v[122:123], v[124:125], v[114:115] op_sel_hi:[1,0]
    v_pk_fma_f32 v[124:125], v[124:125], v[114:115], v[122:123] op_sel:[1,1,0] op_sel_hi:[0,1,1] neg_lo:[0,1,0]
    v_cvt_pk_bf16_f32 v129, v124, v125
    ds_write_addtid_b32 v129 offset:17872
    v_pk_mul_f32 v[122:123], v[124:125], v[114:115] op_sel_hi:[1,0]
    v_pk_fma_f32 v[124:125], v[124:125], v[114:115], v[122:123] op_sel:[1,1,0] op_sel_hi:[0,1,1] neg_lo:[0,1,0]
    v_cvt_pk_bf16_f32 v130, v124, v125
    ds_write_addtid_b32 v130 offset:18144
    v_pk_mul_f32 v[122:123], v[124:125], v[114:115] op_sel_hi:[1,0]
    v_pk_fma_f32 v[124:125], v[124:125], v[114:115], v[122:123] op_sel:[1,1,0] op_sel_hi:[0,1,1] neg_lo:[0,1,0]
    v_cvt_pk_bf16_f32 v131, v124, v125
    ds_write_addtid_b32 v131 offset:18416
    v_pk_mul_f32 v[122:123], v[124:125], v[114:115] op_sel_hi:[1,0]
    v_pk_fma_f32 v[124:125], v[124:125], v[114:115], v[122:123] op_sel:[1,1,0] op_sel_hi:[0,1,1] neg_lo:[0,1,0]
    v_cvt_pk_bf16_f32 v128, v124, v125
    ds_write_addtid_b32 v128 offset:18688
    v_pk_mul_f32 v[122:123], v[124:125], v[114:115] op_sel_hi:[1,0]
    v_pk_fma_f32 v[124:125], v[124:125], v[114:115], v[122:123] op_sel:[1,1,0] op_sel_hi:[0,1,1] neg_lo:[0,1,0]
    v_cvt_pk_bf16_f32 v129, v124, v125
    ds_write_addtid_b32 v129 offset:18960
    v_pk_mul_f32 v[122:123], v[124:125], v[114:115] op_sel_hi:[1,0]
    v_pk_fma_f32 v[124:125], v[124:125], v[114:115], v[122:123] op_sel:[1,1,0] op_sel_hi:[0,1,1] neg_lo:[0,1,0]
    v_cvt_pk_bf16_f32 v130, v124, v125
    ds_write_addtid_b32 v130 offset:19232
    v_pk_mul_f32 v[122:123], v[124:125], v[114:115] op_sel_hi:[1,0]
    v_pk_fma_f32 v[124:125], v[124:125], v[114:115], v[122:123] op_sel:[1,1,0] op_sel_hi:[0,1,1] neg_lo:[0,1,0]
    v_cvt_pk_bf16_f32 v131, v124, v125
    ds_write_addtid_b32 v131 offset:19504
    v_pk_mul_f32 v[122:123], v[124:125], v[114:115] op_sel_hi:[1,0]
    v_pk_fma_f32 v[124:125], v[124:125], v[114:115], v[122:123] op_sel:[1,1,0] op_sel_hi:[0,1,1] neg_lo:[0,1,0]
    v_cvt_pk_bf16_f32 v128, v124, v125
    ds_write_addtid_b32 v128 offset:19776
    v_pk_mul_f32 v[122:123], v[124:125], v[114:115] op_sel_hi:[1,0]
    v_pk_fma_f32 v[124:125], v[124:125], v[114:115], v[122:123] op_sel:[1,1,0] op_sel_hi:[0,1,1] neg_lo:[0,1,0]
    v_cvt_pk_bf16_f32 v129, v124, v125
    ds_write_addtid_b32 v129 offset:20048
    v_pk_mul_f32 v[122:123], v[124:125], v[114:115] op_sel_hi:[1,0]
    v_pk_fma_f32 v[124:125], v[124:125], v[114:115], v[122:123] op_sel:[1,1,0] op_sel_hi:[0,1,1] neg_lo:[0,1,0]
    v_cvt_pk_bf16_f32 v130, v124, v125
    ds_write_addtid_b32 v130 offset:20320
    v_pk_mul_f32 v[122:123], v[124:125], v[114:115] op_sel_hi:[1,0]
    v_pk_fma_f32 v[124:125], v[124:125], v[114:115], v[122:123] op_sel:[1,1,0] op_sel_hi:[0,1,1] neg_lo:[0,1,0]
    v_cvt_pk_bf16_f32 v131, v124, v125
    ds_write_addtid_b32 v131 offset:20592
    v_pk_mul_f32 v[122:123], v[124:125], v[114:115] op_sel_hi:[1,0]
    v_pk_fma_f32 v[124:125], v[124:125], v[114:115], v[122:123] op_sel:[1,1,0] op_sel_hi:[0,1,1] neg_lo:[0,1,0]
    v_cvt_pk_bf16_f32 v128, v124, v125
    ds_write_addtid_b32 v128 offset:20864
    v_pk_mul_f32 v[122:123], v[124:125], v[114:115] op_sel_hi:[1,0]
    v_pk_fma_f32 v[124:125], v[124:125], v[114:115], v[122:123] op_sel:[1,1,0] op_sel_hi:[0,1,1] neg_lo:[0,1,0]
    v_cvt_pk_bf16_f32 v129, v124, v125
    ds_write_addtid_b32 v129 offset:21136
    v_pk_mul_f32 v[122:123], v[124:125], v[114:115] op_sel_hi:[1,0]
    v_pk_fma_f32 v[124:125], v[124:125], v[114:115], v[122:123] op_sel:[1,1,0] op_sel_hi:[0,1,1] neg_lo:[0,1,0]
    v_cvt_pk_bf16_f32 v130, v124, v125
    ds_write_addtid_b32 v130 offset:21408
    v_pk_mul_f32 v[122:123], v[124:125], v[114:115] op_sel_hi:[1,0]
    v_pk_fma_f32 v[124:125], v[124:125], v[114:115], v[122:123] op_sel:[1,1,0] op_sel_hi:[0,1,1] neg_lo:[0,1,0]
    v_cvt_pk_bf16_f32 v131, v124, v125
    ds_write_addtid_b32 v131 offset:21680
    v_pk_mul_f32 v[122:123], v[124:125], v[114:115] op_sel_hi:[1,0]
    v_pk_fma_f32 v[124:125], v[124:125], v[114:115], v[122:123] op_sel:[1,1,0] op_sel_hi:[0,1,1] neg_lo:[0,1,0]
    v_cvt_pk_bf16_f32 v128, v124, v125
    ds_write_addtid_b32 v128 offset:21952
    v_pk_mul_f32 v[122:123], v[124:125], v[114:115] op_sel_hi:[1,0]
    v_pk_fma_f32 v[124:125], v[124:125], v[114:115], v[122:123] op_sel:[1,1,0] op_sel_hi:[0,1,1] neg_lo:[0,1,0]
    v_cvt_pk_bf16_f32 v129, v124, v125
    ds_write_addtid_b32 v129 offset:22224
    v_pk_mul_f32 v[122:123], v[124:125], v[114:115] op_sel_hi:[1,0]
    v_pk_fma_f32 v[124:125], v[124:125], v[114:115], v[122:123] op_sel:[1,1,0] op_sel_hi:[0,1,1] neg_lo:[0,1,0]
    v_cvt_pk_bf16_f32 v130, v124, v125
    ds_write_addtid_b32 v130 offset:22496
    v_pk_mul_f32 v[122:123], v[124:125], v[114:115] op_sel_hi:[1,0]
    v_pk_fma_f32 v[124:125], v[124:125], v[114:115], v[122:123] op_sel:[1,1,0] op_sel_hi:[0,1,1] neg_lo:[0,1,0]
    v_cvt_pk_bf16_f32 v131, v124, v125
    ds_write_addtid_b32 v131 offset:22768
    ds_read_b128 v[160:163], v140 offset:0
    ds_read_b128 v[164:167], v140 offset:32
    ds_read_b128 v[168:171], v140 offset:64
    ds_read_b128 v[172:175], v140 offset:96
    ds_read_b128 v[176:179], v140 offset:128
    ds_read_b128 v[180:183], v140 offset:160
    ds_read_b128 v[184:187], v140 offset:192
    ds_read_b128 v[188:191], v140 offset:224
    s_cmp_eq_u32 s1, 0
    s_cbranch_scc1 L_rw_8
    s_waitcnt vmcnt(0)
L_rw_8:
    s_waitcnt vmcnt(8)
    v_perm_b32 v102, v102, v102, s47
    v_perm_b32 v103, v103, v103, s47
    v_perm_b32 v104, v104, v104, s47
    v_perm_b32 v105, v105, v105, s47
    v_pk_mul_f32 v[122:123], v[102:103], v[104:105] op_sel_hi:[1,0]
    v_pk_fma_f32 v[126:127], v[102:103], v[104:105], v[122:123] op_sel:[1,1,0] op_sel_hi:[0,1,1] neg_lo:[0,1,0]
    v_pk_mul_f32 v[126:127], v[126:127], v[148:149] op_sel_hi:[1,0]
    v_cvt_pk_bf16_f32 v128, v126, -v127
    ds_write_addtid_b32 v128 offset:14336
    v_pk_mul_f32 v[122:123], v[112:113], v[112:113] op_sel_hi:[1,0]
    v_pk_fma_f32 v[118:119], v[112:113], v[112:113], v[122:123] op_sel:[1,1,0] op_sel_hi:[0,1,1] neg_lo:[0,1,0]
    v_pk_mul_f32 v[122:123], v[118:119], v[118:119] op_sel_hi:[1,0]
    v_pk_fma_f32 v[120:121], v[118:119], v[118:119], v[122:123] op_sel:[1,1,0] op_sel_hi:[0,1,1] neg_lo:[0,1,0]
    v_pk_mul_f32 v[122:123], v[126:127], v[112:113] op_sel_hi:[1,0]
    v_pk_fma_f32 v[124:125], v[126:127], v[112:113], v[122:123] op_sel:[1,1,0] op_sel_hi:[0,1,1] neg_lo:[0,1,0]
    v_cvt_pk_bf16_f32 v129, v124, -v125
    ds_write_addtid_b32 v129 offset:14608
    v_pk_mul_f32 v[122:123], v[124:125], v[112:113] op_sel_hi:[1,0]
    v_pk_fma_f32 v[124:125], v[124:125], v[112:113], v[122:123] op_sel:[1,1,0] op_sel_hi:[0,1,1] neg_lo:[0,1,0]
    v_cvt_pk_bf16_f32 v130, v124, -v125
    ds_write_addtid_b32 v130 offset:14880
    v_pk_mul_f32 v[122:123], v[124:125], v[112:113] op_sel_hi:[1,0]
    v_pk_fma_f32 v[124:125], v[124:125], v[112:113], v[122:123] op_sel:[1,1,0] op_sel_hi:[0,1,1] neg_lo:[0,1,0]
    v_cvt_pk_bf16_f32 v131, v124, -v125
    ds_write_addtid_b32 v131 offset:15152
    v_pk_mul_f32 v[122:123], v[124:125], v[112:113] op_sel_hi:[1,0]
    v_pk_fma_f32 v[124:125], v[124:125], v[112:113], v[122:123] op_sel:[1,1,0] op_sel_hi:[0,1,1] neg_lo:[0,1,0]
    v_cvt_pk_bf16_f32 v128, v124, -v125
    ds_write_addtid_b32 v128 offset:15424
    s_cmp_eq_u32 s1, 1
    s_cbranch_scc1 L_g_9
    buffer_load_dword v99, v132, s[8:11], s77 offen offset:0
    buffer_load_dword v99, v133, s[8:11], s77 offen offset:1024
    buffer_load_dword v99, v134, s[8:11], s77 offen offset:2048
    buffer_load_dword v99, v135, s[8:11], s77 offen offset:3072
L_g_9:
    v_pk_mul_f32 v[122:123], v[124:125], v[112:113] op_sel_hi:[1,0]
    v_pk_fma_f32 v[124:125], v[124:125], v[112:113], v[122:123] op_sel:[1,1,0] op_sel_hi:[0,1,1] neg_lo:[0,1,0]
    v_cvt_pk_bf16_f32 v129, v124, -v125
    ds_write_addtid_b32 v129 offset:15696
    v_pk_mul_f32 v[122:123], v[124:125], v[112:113] op_sel_hi:[1,0]
    v_pk_fma_f32 v[124:125], v[124:125], v[112:113], v[122:123] op_sel:[1,1,0] op_sel_hi:[0,1,1] neg_lo:[0,1,0]
    v_cvt_pk_bf16_f32 v130, v124, -v125
    ds_write_addtid_b32 v130 offset:15968
    v_pk_mul_f32 v[122:123], v[124:125], v[112:113] op_sel_hi:[1,0]
    v_pk_fma_f32 v[124:125], v[124:125], v[112:113], v[122:123] op_sel:[1,1,0] op_sel_hi:[0,1,1] neg_lo:[0,1,0]
    v_cvt_pk_bf16_f32 v131, v124, -v125
    ds_write_addtid_b32 v131 offset:16240
    v_pk_mul_f32 v[122:123], v[126:127], v[116:117] op_sel_hi:[1,0]
    v_pk_fma_f32 v[126:127], v[126:127], v[116:117], v[122:123] op_sel:[1,1,0] op_sel_hi:[0,1,1] neg_lo:[0,1,0]
    v_cvt_pk_bf16_f32 v128, v126, -v127
    ds_write_addtid_b32 v128 offset:16512
    v_pk_mul_f32 v[122:123], v[126:127], v[118:119] op_sel_hi:[1,0]
    v_pk_fma_f32 v[124:125], v[126:127], v[118:119], v[122:123] op_sel:[1,1,0] op_sel_hi:[0,1,1] neg_lo:[0,1,0]
    v_cvt_pk_bf16_f32 v129, v124, -v125
    ds_write_addtid_b32 v129 offset:16784
    v_pk_mul_f32 v[122:123], v[124:125], v[118:119] op_sel_hi:[1,0]
    v_pk_fma_f32 v[124:125], v[124:125], v[118:119], v[122:123] op_sel:[1,1,0] op_sel_hi:[0,1,1] neg_lo:[0,1,0]
    v_cvt_pk_bf16_f32 v130, v124, -v125
    ds_write_addtid_b32 v130 offset:17056
    v_pk_mul_f32 v[122:123], v[124:125], v[118:119] op_sel_hi:[1,0]
    v_pk_fma_f32 v[124:125], v[124:125], v[118:119], v[122:123] op_sel:[1,1,0] op_sel_hi:[0,1,1] neg_lo:[0,1,0]
    v_cvt_pk_bf16_f32 v131, v124, -v125
    ds_write_addtid_b32 v131 offset:17328
    v_pk_mul_f32 v[122:123], v[126:127], v[116:117] op_sel_hi:[1,0]
    v_pk_fma_f32 v[126:127], v[126:127], v[116:117], v[122:123] op_sel:[1,1,0] op_sel_hi:[0,1,1] neg_lo:[0,1,0]
    v_cvt_pk_bf16_f32 v128, v126, -v127
    ds_write_addtid_b32 v128 offset:17600
    v_pk_mul_f32 v[122:123], v[126:127], v[120:121] op_sel_hi:[1,0]
    v_pk_fma_f32 v[124:125], v[126:127], v[120:121], v[122:123] op_sel:[1,1,0] op_sel_hi:[0,1,1] neg_lo:[0,1,0]
    v_cvt_pk_bf16_f32 v129, v124, -v125
    ds_write_addtid_b32 v129 offset:17872
    v_pk_mul_f32 v[122:123], v[126:127], v[116:117] op_sel_hi:[1,0]
    v_pk_fma_f32 v[126:127], v[126:127], v[116:117], v[122:123] op_sel:[1,1,0] op_sel_hi:[0,1,1] neg_lo:[0,1,0]
    v_cvt_pk_bf16_f32 v130, v126, -v127
    ds_write_addtid_b32 v130 offset:18144
    v_pk_mul_f32 v[122:123], v[126:127], v[120:121] op_sel_hi:[1,0]
    v_pk_fma_f32 v[124:125], v[126:127], v[120:121], v[122:123] op_sel:[1,1,0] op_sel_hi:[0,1,1] neg_lo:[0,1,0]
    v_cvt_pk_bf16_f32 v131, v124, -v125
    ds_write_addtid_b32 v131 offset:18416
    v_pk_mul_f32 v[122:123], v[126:127], v[116:117] op_sel_hi:[1,0]
    v_pk_fma_f32 v[126:127], v[126:127], v[116:117], v[122:123] op_sel:[1,1,0] op_sel_hi:[0,1,1] neg_lo:[0,1,0]
    v_cvt_pk_bf16_f32 v128, v126, -v127
    ds_write_addtid_b32 v128 offset:18688
    v_pk_mul_f32 v[122:123], v[126:127], v[116:117] op_sel_hi:[1,0]
    v_pk_fma_f32 v[126:127], v[126:127], v[116:117], v[122:123] op_sel:[1,1,0] op_sel_hi:[0,1,1] neg_lo:[0,1,0]
    v_cvt_pk_bf16_f32 v129, v126, -v127
    ds_write_addtid_b32 v129 offset:18960
    v_pk_mul_f32 v[122:123], v[126:127], v[116:117] op_sel_hi:[1,0]
    v_pk_fma_f32 v[126:127], v[126:127], v[116:117], v[122:123] op_sel:[1,1,0] op_sel_hi:[0,1,1] neg_lo:[0,1,0]
    v_cvt_pk_bf16_f32 v130, v126, -v127
    ds_write_addtid_b32 v130 offset:19232
    s_cmp_eq_u32 s1, 1
    s_cbranch_scc1 L_g_10
    s_waitcnt vmcnt(8)
    ds_read_b64_tr_b16 v[56:57], v44
    ds_read_b64_tr_b16 v[58:59], v45 offset:512
    ds_read_b64_tr_b16 v[60:61], v45
    ds_read_b64_tr_b16 v[62:63], v44 offset:512
L_g_10:
    v_pk_mul_f32 v[122:123], v[126:127], v[116:117] op_sel_hi:[1,0]
    v_pk_fma_f32 v[126:127], v[126:127], v[116:117], v[122:123] op_sel:[1,1,0] op_sel_hi:[0,1,1] neg_lo:[0,1,0]
    v_cvt_pk_bf16_f32 v131, v126, -v127
    ds_write_addtid_b32 v131 offset:19504
    v_pk_mul_f32 v[122:123], v[126:127], v[116:117] op_sel_hi:[1,0]
    v_pk_fma_f32 v[126:127], v[126:127], v[116:117], v[122:123] op_sel:[1,1,0] op_sel_hi:[0,1,1] neg_lo:[0,1,0]
    v_cvt_pk_bf16_f32 v128, v126, -v127
    ds_write_addtid_b32 v128 offset:19776
    s_cmp_eq_u32 s1, 1
    s_cbranch_scc1 L_g_11
    s_waitcnt lgkmcnt(2)
    buffer_store_dwordx4 v[56:59], v46, s[16:19], s37 offen sc1
    buffer_store_dwordx4 v[60:63], v46, s[16:19], s38 offen sc1
L_g_11:
    ds_read_b128 v[192:195], v140 offset:0
    ds_read_b128 v[196:199], v140 offset:32
    ds_read_b128 v[200:203], v140 offset:64
    ds_read_b128 v[204:207], v140 offset:96
    ds_read_b128 v[208:211], v140 offset:128
    ds_read_b128 v[212:215], v140 offset:160
    ds_read_b128 v[216:219], v140 offset:192
    ds_read_b128 v[220:223], v140 offset:224
    s_cmp_eq_u32 s1, 1
    s_cbranch_scc1 L_S
    s_lshl_b32 s71, s68, 4
    s_lshr_b32 s75, s75, s71
    s_lshl_b32 s75, s75, 16
    s_cmp_eq_u32 s40, 0
    s_cselect_b32 s75, s75, 0
    v_mov_b32 v154, s75
    v_cmp_eq_u32 vcc, 0, v0
    s_mov_b64 s[12:13], s[52:53]
    s_mov_b32 s14, 1605632
    s_mov_b32 s15, 0x20000
    v_cndmask_b32 v145, 0, v154, vcc
    s_xor_b32 s71, s3, s60
    s_waitcnt lgkmcnt(7)
    v_mfma_f32_32x32x16_bf16 v[224:239], v[192:195], v[160:163], 0
    s_bitcmp1_b32 s71, 0
    s_cselect_b32 s43, 0, s63
    s_and_b32 s71, s3, 1
    s_mul_i32 s71, s71, 14
    s_add_u32 s71, s71, s68
    s_waitcnt lgkmcnt(6)
    v_mfma_f32_32x32x16_bf16 v[224:239], v[196:199], v[164:167], v[224:239]
    s_mul_i32 s32, s71, 57344
    s_lshl_b32 s71, s66, 7
    s_add_u32 s32, s32, s71
    s_add_u32 s33, s32, 114688
    s_mul_i32 s42, s43, 114688
    s_waitcnt lgkmcnt(5)
    v_mfma_f32_32x32x16_bf16 v[224:239], v[200:203], v[168:171], v[224:239]
    s_add_u32 s42, s42, s32
    v_lshrrev_b32 v154, 3, v0
    v_and_b32 v155, 7, v0
    v_bfe_u32 v156, v0, 4, 2
    v_lshlrev_b32 v156, 1, v156
    s_waitcnt lgkmcnt(4)
    v_mfma_f32_32x32x16_bf16 v[224:239], v[204:207], v[172:175], v[224:239]
    v_xor_b32 v155, v155, v156
    v_mul_u32_u24 v154, 896, v154
    v_lshl_add_u32 v1, v155, 4, v154
    v_add_u32 v2, 6144, v1
    v_add_u32 v3, 12288, v1
    s_waitcnt lgkmcnt(3)
    v_mfma_f32_32x32x16_bf16 v[224:239], v[208:211], v[176:179], v[224:239]
    v_add_u32 v4, 18432, v1
    v_subrev_u32 v86, 81920, v82
    v_subrev_u32 v87, 81920, v83
    v_subrev_u32 v88, 81920, v84
    v_subrev_u32 v89, 81920, v85
    s_waitcnt lgkmcnt(2)
    v_mfma_f32_32x32x16_bf16 v[224:239], v[212:215], v[180:183], v[224:239]
    v_lshrrev_b32 v13, 2, v0
    v_lshl_add_u32 v12, v13, 7, v11
    v_bfe_u32 v13, v0, 3, 2
    v_lshl_add_u32 v12, v13, 5, v12
    v_add_u32 v5, s70, v12
    s_waitcnt lgkmcnt(1)
    v_mfma_f32_32x32x16_bf16 v[224:239], v[216:219], v[184:187], v[224:239]
    v_xor_b32 v6, 32, v5
    v_xor_b32 v7, 64, v5
    v_xor_b32 v8, 96, v5
    v_mul_u32_u24 v13, 384, v14
    s_mul_i32 s71, s68, 768
    s_waitcnt lgkmcnt(0)
    v_mfma_f32_32x32x16_bf16 v[224:239], v[220:223], v[188:191], v[224:239]
    s_branch L_g1
    .p2align 12
L_pad_g1:
    s_branch L_ret_g1
L_g1:
    s_add_u32 s71, s71, 9216
    v_lshl_add_u32 v12, v15, 3, s71
    v_add_u32 v92, v12, v13
    s_mul_i32 s71, s40, 768
    s_add_u32 s71, s71, 9472
    v_lshl_add_u32 v12, v15, 2, s71
    v_add_u32 v91, v12, v13
    v_and_b32 v12, 15, v0
    v_lshl_add_u32 v90, v12, 2, s71
    v_lshlrev_b32 v9, 4, v0
    v_mov_b32 v12, 13312
    v_mov_b32 v13, 1
    v_lshl_add_u32 v10, s69, 2, v12
    v_add_f32 v224, v224, v145
    ds_write_b128 v141, v[228:231] offset:1024
    ds_write_b128 v141, v[232:235] offset:2048
    ds_write_b128 v141, v[224:227] offset:0
    s_add_u32 m0, s70, 65536
    s_nop 0
    buffer_load_dwordx4 v150, s[4:7], s76 offen offset:0 lds
    buffer_load_dwordx4 v151, s[4:7], s76 offen offset:1024 lds
    buffer_load_dwordx4 v152, s[4:7], s76 offen offset:2048 lds
    buffer_load_dwordx4 v153, s[4:7], s76 offen offset:3072 lds
    s_lshl1_add_u32 s36, s64, s40
    s_lshl1_add_u32 s30, s65, s68
    s_lshl1_add_u32 s31, s36, s68
    s_lshl1_add_u32 s31, s31, s61
    s_lshr_b32 s71, s63, 1
    s_lshl2_add_u32 s31, s31, s71
    s_lshl_b32 s31, s31, 7
    s_add_u32 s31, s31, 65536
    s_lshl_b32 s30, s30, 13
    s_mul_i32 s71, s36, 229376
    s_add_u32 s30, s30, s71
    s_add_u32 s30, s30, 5242880
    s_add_u32 s39, s30, 4096
    s_waitcnt vmcnt(10)
    s_barrier
    s_setprio 2
    ds_read_b64_tr_b16 v[116:117], v82 offset:0
    ds_read_b64_tr_b16 v[118:119], v82 offset:1024
    ds_read_b128 v[100:103], v80 offset:32768
    ds_read_b128 v[104:107], v80 offset:34816
    ds_read_b128 v[108:111], v80 offset:36864
    ds_read_b128 v[112:115], v80 offset:38912
    ds_read_b64_tr_b16 v[120:121], v83 offset:0
    ds_read_b64_tr_b16 v[122:123], v83 offset:1024
    ds_read_b64_tr_b16 v[124:125], v84 offset:0
    ds_read_b64_tr_b16 v[126:127], v84 offset:1024
    ds_read_b64_tr_b16 v[128:129], v85 offset:0
    ds_read_b64_tr_b16 v[130:131], v85 offset:1024
    s_waitcnt lgkmcnt(9)
    v_mfma_f32_16x16x32_bf16 v[16:19], v[116:119], v[100:103], 0
    s_waitcnt lgkmcnt(8)
    v_mfma_f32_16x16x32_bf16 v[20:23], v[116:119], v[104:107], 0
    ds_read_b64_tr_b16 v[148:149], v82 offset:8192
    s_waitcnt lgkmcnt(8)
    v_mfma_f32_16x16x32_bf16 v[24:27], v[116:119], v[108:111], 0
    ds_read_b64_tr_b16 v[150:151], v82 offset:9216
    s_waitcnt lgkmcnt(8)
    v_mfma_f32_16x16x32_bf16 v[28:31], v[116:119], v[112:115], 0
    ds_read_b128 v[132:135], v81 offset:32768
    s_waitcnt lgkmcnt(7)
    v_mfma_f32_16x16x32_bf16 v[32:35], v[120:123], v[100:103], 0
    ds_read_b128 v[136:139], v81 offset:34816
    v_mfma_f32_16x16x32_bf16 v[36:39], v[120:123], v[104:107], 0
    ds_read_b128 v[140:143], v81 offset:36864
    v_mfma_f32_16x16x32_bf16 v[40:43], v[120:123], v[108:111], 0
    ds_read_b128 v[144:147], v81 offset:38912
    v_mfma_f32_16x16x32_bf16 v[44:47], v[120:123], v[112:115], 0
    ds_read_b64_tr_b16 v[152:153], v83 offset:8192
    s_waitcnt lgkmcnt(9)
    v_mfma_f32_16x16x32_bf16 v[48:51], v[124:127], v[100:103], 0
    ds_read_b64_tr_b16 v[154:155], v83 offset:9216
    v_mfma_f32_16x16x32_bf16 v[52:55], v[124:127], v[104:107], 0
    ds_read_b64_tr_b16 v[156:157], v84 offset:8192
    v_mfma_f32_16x16x32_bf16 v[56:59], v[124:127], v[108:111], 0
    ds_read_b64_tr_b16 v[158:159], v84 offset:9216
    v_mfma_f32_16x16x32_bf16 v[60:63], v[124:127], v[112:115], 0
    ds_read_b64_tr_b16 v[160:161], v85 offset:8192
    s_waitcnt lgkmcnt(11)
    v_mfma_f32_16x16x32_bf16 v[64:67], v[128:131], v[100:103], 0
    ds_read_b64_tr_b16 v[162:163], v85 offset:9216
    v_mfma_f32_16x16x32_bf16 v[68:71], v[128:131], v[104:107], 0
    v_mfma_f32_16x16x32_bf16 v[72:75], v[128:131], v[108:111], 0
    v_mfma_f32_16x16x32_bf16 v[76:79], v[128:131], v[112:115], 0
    s_waitcnt lgkmcnt(6)
    v_mfma_f32_16x16x32_bf16 v[16:19], v[148:151], v[132:135], v[16:19]
    v_mfma_f32_16x16x32_bf16 v[20:23], v[148:151], v[136:139], v[20:23]
    v_mfma_f32_16x16x32_bf16 v[24:27], v[148:151], v[140:143], v[24:27]
    v_mfma_f32_16x16x32_bf16 v[28:31], v[148:151], v[144:147], v[28:31]
    s_waitcnt vmcnt(0) lgkmcnt(0)
    s_barrier
    v_mfma_f32_16x16x32_bf16 v[32:35], v[152:155], v[132:135], v[32:35]
    ds_read_b64_tr_b16 v[116:117], v82 offset:16384
    v_mfma_f32_16x16x32_bf16 v[36:39], v[152:155], v[136:139], v[36:39]
    ds_read_b64_tr_b16 v[118:119], v82 offset:17408
    v_mfma_f32_16x16x32_bf16 v[40:43], v[152:155], v[140:143], v[40:43]
    ds_read_b128 v[100:103], v80 offset:49152
    v_mfma_f32_16x16x32_bf16 v[44:47], v[152:155], v[144:147], v[44:47]
    ds_read_b128 v[104:107], v80 offset:51200
    v_mfma_f32_16x16x32_bf16 v[48:51], v[156:159], v[132:135], v[48:51]
    ds_read_b128 v[108:111], v80 offset:53248
    v_mfma_f32_16x16x32_bf16 v[52:55], v[156:159], v[136:139], v[52:55]
    ds_read_b128 v[112:115], v80 offset:55296
    v_mfma_f32_16x16x32_bf16 v[56:59], v[156:159], v[140:143], v[56:59]
    ds_read_b64_tr_b16 v[120:121], v83 offset:16384
    v_mfma_f32_16x16x32_bf16 v[60:63], v[156:159], v[144:147], v[60:63]
    ds_read_b64_tr_b16 v[122:123], v83 offset:17408
    v_mfma_f32_16x16x32_bf16 v[64:67], v[160:163], v[132:135], v[64:67]
    ds_read_b64_tr_b16 v[124:125], v84 offset:16384
    v_mfma_f32_16x16x32_bf16 v[68:71], v[160:163], v[136:139], v[68:71]
    ds_read_b64_tr_b16 v[126:127], v84 offset:17408
    v_mfma_f32_16x16x32_bf16 v[72:75], v[160:163], v[140:143], v[72:75]
    ds_read_b64_tr_b16 v[128:129], v85 offset:16384
    v_mfma_f32_16x16x32_bf16 v[76:79], v[160:163], v[144:147], v[76:79]
    ds_read_b64_tr_b16 v[130:131], v85 offset:17408
    s_waitcnt lgkmcnt(6)
    v_mfma_f32_16x16x32_bf16 v[16:19], v[116:119], v[100:103], v[16:19]
    v_mfma_f32_16x16x32_bf16 v[20:23], v[116:119], v[104:107], v[20:23]
    ds_read_b64_tr_b16 v[148:149], v82 offset:24576
    v_mfma_f32_16x16x32_bf16 v[24:27], v[116:119], v[108:111], v[24:27]
    ds_read_b64_tr_b16 v[150:151], v82 offset:25600
    v_mfma_f32_16x16x32_bf16 v[28:31], v[116:119], v[112:115], v[28:31]
    ds_read_b128 v[132:135], v81 offset:49152
    s_waitcnt lgkmcnt(7)
    v_mfma_f32_16x16x32_bf16 v[32:35], v[120:123], v[100:103], v[32:35]
    ds_read_b128 v[136:139], v81 offset:51200
    v_mfma_f32_16x16x32_bf16 v[36:39], v[120:123], v[104:107], v[36:39]
    ds_read_b128 v[140:143], v81 offset:53248
    v_mfma_f32_16x16x32_bf16 v[40:43], v[120:123], v[108:111], v[40:43]
    ds_read_b128 v[144:147], v81 offset:55296
    v_mfma_f32_16x16x32_bf16 v[44:47], v[120:123], v[112:115], v[44:47]
    ds_read_b64_tr_b16 v[152:153], v83 offset:24576
    s_waitcnt lgkmcnt(9)
    v_mfma_f32_16x16x32_bf16 v[48:51], v[124:127], v[100:103], v[48:51]
    ds_read_b64_tr_b16 v[154:155], v83 offset:25600
    v_mfma_f32_16x16x32_bf16 v[52:55], v[124:127], v[104:107], v[52:55]
    ds_read_b64_tr_b16 v[156:157], v84 offset:24576
    v_mfma_f32_16x16x32_bf16 v[56:59], v[124:127], v[108:111], v[56:59]
    ds_read_b64_tr_b16 v[158:159], v84 offset:25600
    v_mfma_f32_16x16x32_bf16 v[60:63], v[124:127], v[112:115], v[60:63]
    ds_read_b64_tr_b16 v[160:161], v85 offset:24576
    s_waitcnt lgkmcnt(11)
    v_mfma_f32_16x16x32_bf16 v[64:67], v[128:131], v[100:103], v[64:67]
    ds_read_b64_tr_b16 v[162:163], v85 offset:25600
    v_mfma_f32_16x16x32_bf16 v[68:71], v[128:131], v[104:107], v[68:71]
    v_mfma_f32_16x16x32_bf16 v[72:75], v[128:131], v[108:111], v[72:75]
    v_mfma_f32_16x16x32_bf16 v[76:79], v[128:131], v[112:115], v[76:79]
    s_waitcnt lgkmcnt(6)
    v_mfma_f32_16x16x32_bf16 v[16:19], v[148:151], v[132:135], v[16:19]
    v_mfma_f32_16x16x32_bf16 v[20:23], v[148:151], v[136:139], v[20:23]
    v_mfma_f32_16x16x32_bf16 v[24:27], v[148:151], v[140:143], v[24:27]
    v_mfma_f32_16x16x32_bf16 v[28:31], v[148:151], v[144:147], v[28:31]
    s_waitcnt lgkmcnt(0)
    s_barrier
    v_mfma_f32_16x16x32_bf16 v[32:35], v[152:155], v[132:135], v[32:35]
    ds_read_b64_tr_b16 v[116:117], v86 offset:0
    v_mfma_f32_16x16x32_bf16 v[36:39], v[152:155], v[136:139], v[36:39]
    ds_read_b64_tr_b16 v[118:119], v86 offset:1024
    v_mfma_f32_16x16x32_bf16 v[40:43], v[152:155], v[140:143], v[40:43]
    ds_read_b128 v[100:103], v80 offset:0
    v_mfma_f32_16x16x32_bf16 v[44:47], v[152:155], v[144:147], v[44:47]
    ds_read_b128 v[104:107], v80 offset:2048
    v_mfma_f32_16x16x32_bf16 v[48:51], v[156:159], v[132:135], v[48:51]
    ds_read_b128 v[108:111], v80 offset:4096
    v_mfma_f32_16x16x32_bf16 v[52:55], v[156:159], v[136:139], v[52:55]
    ds_read_b128 v[112:115], v80 offset:6144
    v_mfma_f32_16x16x32_bf16 v[56:59], v[156:159], v[140:143], v[56:59]
    ds_read_b64_tr_b16 v[120:121], v87 offset:0
    v_mfma_f32_16x16x32_bf16 v[60:63], v[156:159], v[144:147], v[60:63]
    ds_read_b64_tr_b16 v[122:123], v87 offset:1024
    v_mfma_f32_16x16x32_bf16 v[64:67], v[160:163], v[132:135], v[64:67]
    ds_read_b64_tr_b16 v[124:125], v88 offset:0
    v_mfma_f32_16x16x32_bf16 v[68:71], v[160:163], v[136:139], v[68:71]
    ds_read_b64_tr_b16 v[126:127], v88 offset:1024
    v_mfma_f32_16x16x32_bf16 v[72:75], v[160:163], v[140:143], v[72:75]
    ds_read_b64_tr_b16 v[128:129], v89 offset:0
    v_mfma_f32_16x16x32_bf16 v[76:79], v[160:163], v[144:147], v[76:79]
    ds_read_b64_tr_b16 v[130:131], v89 offset:1024
    s_waitcnt lgkmcnt(6)
    v_mfma_f32_16x16x32_bf16 v[16:19], v[116:119], v[100:103], v[16:19]
    v_mfma_f32_16x16x32_bf16 v[20:23], v[116:119], v[104:107], v[20:23]
    ds_read_b64_tr_b16 v[148:149], v86 offset:8192
    v_mfma_f32_16x16x32_bf16 v[24:27], v[116:119], v[108:111], v[24:27]
    ds_read_b64_tr_b16 v[150:151], v86 offset:9216
    v_mfma_f32_16x16x32_bf16 v[28:31], v[116:119], v[112:115], v[28:31]
    ds_read_b128 v[132:135], v81 offset:0
    s_waitcnt lgkmcnt(7)
    v_mfma_f32_16x16x32_bf16 v[32:35], v[120:123], v[100:103], v[32:35]
    ds_read_b128 v[136:139], v81 offset:2048
    v_mfma_f32_16x16x32_bf16 v[36:39], v[120:123], v[104:107], v[36:39]
    ds_read_b128 v[140:143], v81 offset:4096
    v_mfma_f32_16x16x32_bf16 v[40:43], v[120:123], v[108:111], v[40:43]
    ds_read_b128 v[144:147], v81 offset:6144
    v_mfma_f32_16x16x32_bf16 v[44:47], v[120:123], v[112:115], v[44:47]
    ds_read_b64_tr_b16 v[152:153], v87 offset:8192
    s_waitcnt lgkmcnt(9)
    v_mfma_f32_16x16x32_bf16 v[48:51], v[124:127], v[100:103], v[48:51]
    ds_read_b64_tr_b16 v[154:155], v87 offset:9216
    v_mfma_f32_16x16x32_bf16 v[52:55], v[124:127], v[104:107], v[52:55]
    ds_read_b64_tr_b16 v[156:157], v88 offset:8192
    v_mfma_f32_16x16x32_bf16 v[56:59], v[124:127], v[108:111], v[56:59]
    ds_read_b64_tr_b16 v[158:159], v88 offset:9216
    v_mfma_f32_16x16x32_bf16 v[60:63], v[124:127], v[112:115], v[60:63]
    ds_read_b64_tr_b16 v[160:161], v89 offset:8192
    s_waitcnt lgkmcnt(11)
    v_mfma_f32_16x16x32_bf16 v[64:67], v[128:131], v[100:103], v[64:67]
    ds_read_b64_tr_b16 v[162:163], v89 offset:9216
    v_mfma_f32_16x16x32_bf16 v[68:71], v[128:131], v[104:107], v[68:71]
    v_mfma_f32_16x16x32_bf16 v[72:75], v[128:131], v[108:111], v[72:75]
    v_mfma_f32_16x16x32_bf16 v[76:79], v[128:131], v[112:115], v[76:79]
    s_waitcnt lgkmcnt(6)
    v_mfma_f32_16x16x32_bf16 v[16:19], v[148:151], v[132:135], v[16:19]
    v_mfma_f32_16x16x32_bf16 v[20:23], v[148:151], v[136:139], v[20:23]
    v_mfma_f32_16x16x32_bf16 v[24:27], v[148:151], v[140:143], v[24:27]
    v_mfma_f32_16x16x32_bf16 v[28:31], v[148:151], v[144:147], v[28:31]
    s_waitcnt lgkmcnt(0)
    s_barrier
    v_mfma_f32_16x16x32_bf16 v[32:35], v[152:155], v[132:135], v[32:35]
    ds_read_b64_tr_b16 v[116:117], v82 offset:0
    v_mfma_f32_16x16x32_bf16 v[36:39], v[152:155], v[136:139], v[36:39]
    ds_read_b64_tr_b16 v[118:119], v82 offset:1024
    v_mfma_f32_16x16x32_bf16 v[40:43], v[152:155], v[140:143], v[40:43]
    ds_read_b128 v[100:103], v80 offset:32768
    v_mfma_f32_16x16x32_bf16 v[44:47], v[152:155], v[144:147], v[44:47]
    ds_read_b128 v[104:107], v80 offset:34816
    v_mfma_f32_16x16x32_bf16 v[48:51], v[156:159], v[132:135], v[48:51]
    ds_read_b128 v[108:111], v80 offset:36864
    v_mfma_f32_16x16x32_bf16 v[52:55], v[156:159], v[136:139], v[52:55]
    ds_read_b128 v[112:115], v80 offset:38912
    v_mfma_f32_16x16x32_bf16 v[56:59], v[156:159], v[140:143], v[56:59]
    ds_read_b64_tr_b16 v[120:121], v83 offset:0
    v_mfma_f32_16x16x32_bf16 v[60:63], v[156:159], v[144:147], v[60:63]
    ds_read_b64_tr_b16 v[122:123], v83 offset:1024
    v_mfma_f32_16x16x32_bf16 v[64:67], v[160:163], v[132:135], v[64:67]
    ds_read_b64_tr_b16 v[124:125], v84 offset:0
    v_mfma_f32_16x16x32_bf16 v[68:71], v[160:163], v[136:139], v[68:71]
    ds_read_b64_tr_b16 v[126:127], v84 offset:1024
    v_mfma_f32_16x16x32_bf16 v[72:75], v[160:163], v[140:143], v[72:75]
    ds_read_b64_tr_b16 v[128:129], v85 offset:0
    v_mfma_f32_16x16x32_bf16 v[76:79], v[160:163], v[144:147], v[76:79]
    ds_read_b64_tr_b16 v[130:131], v85 offset:1024
    s_waitcnt lgkmcnt(6)
    v_mfma_f32_16x16x32_bf16 v[16:19], v[116:119], v[100:103], v[16:19]
    v_mfma_f32_16x16x32_bf16 v[20:23], v[116:119], v[104:107], v[20:23]
    ds_read_b64_tr_b16 v[148:149], v82 offset:8192
    v_mfma_f32_16x16x32_bf16 v[24:27], v[116:119], v[108:111], v[24:27]
    ds_read_b64_tr_b16 v[150:151], v82 offset:9216
    v_mfma_f32_16x16x32_bf16 v[28:31], v[116:119], v[112:115], v[28:31]
    ds_read_b128 v[132:135], v81 offset:32768
    s_waitcnt lgkmcnt(7)
    v_mfma_f32_16x16x32_bf16 v[32:35], v[120:123], v[100:103], v[32:35]
    ds_read_b128 v[136:139], v81 offset:34816
    v_mfma_f32_16x16x32_bf16 v[36:39], v[120:123], v[104:107], v[36:39]
    ds_read_b128 v[140:143], v81 offset:36864
    v_mfma_f32_16x16x32_bf16 v[40:43], v[120:123], v[108:111], v[40:43]
    ds_read_b128 v[144:147], v81 offset:38912
    v_mfma_f32_16x16x32_bf16 v[44:47], v[120:123], v[112:115], v[44:47]
    ds_read_b64_tr_b16 v[152:153], v83 offset:8192
    s_waitcnt lgkmcnt(9)
    v_mfma_f32_16x16x32_bf16 v[48:51], v[124:127], v[100:103], v[48:51]
    ds_read_b64_tr_b16 v[154:155], v83 offset:9216
    v_mfma_f32_16x16x32_bf16 v[52:55], v[124:127], v[104:107], v[52:55]
    ds_read_b64_tr_b16 v[156:157], v84 offset:8192
    v_mfma_f32_16x16x32_bf16 v[56:59], v[124:127], v[108:111], v[56:59]
    ds_read_b64_tr_b16 v[158:159], v84 offset:9216
    v_mfma_f32_16x16x32_bf16 v[60:63], v[124:127], v[112:115], v[60:63]
    ds_read_b64_tr_b16 v[160:161], v85 offset:8192
    s_waitcnt lgkmcnt(11)
    v_mfma_f32_16x16x32_bf16 v[64:67], v[128:131], v[100:103], v[64:67]
    ds_read_b64_tr_b16 v[162:163], v85 offset:9216
    v_mfma_f32_16x16x32_bf16 v[68:71], v[128:131], v[104:107], v[68:71]
    v_mfma_f32_16x16x32_bf16 v[72:75], v[128:131], v[108:111], v[72:75]
    v_mfma_f32_16x16x32_bf16 v[76:79], v[128:131], v[112:115], v[76:79]
    s_waitcnt lgkmcnt(6)
    v_mfma_f32_16x16x32_bf16 v[16:19], v[148:151], v[132:135], v[16:19]
    v_mfma_f32_16x16x32_bf16 v[20:23], v[148:151], v[136:139], v[20:23]
    v_mfma_f32_16x16x32_bf16 v[24:27], v[148:151], v[140:143], v[24:27]
    v_mfma_f32_16x16x32_bf16 v[28:31], v[148:151], v[144:147], v[28:31]
    s_waitcnt lgkmcnt(0)
    s_barrier
    v_mfma_f32_16x16x32_bf16 v[32:35], v[152:155], v[132:135], v[32:35]
    ds_read_b64_tr_b16 v[116:117], v82 offset:16384
    v_mfma_f32_16x16x32_bf16 v[36:39], v[152:155], v[136:139], v[36:39]
    ds_read_b64_tr_b16 v[118:119], v82 offset:17408
    v_mfma_f32_16x16x32_bf16 v[40:43], v[152:155], v[140:143], v[40:43]
    ds_read_b128 v[100:103], v80 offset:49152
    v_mfma_f32_16x16x32_bf16 v[44:47], v[152:155], v[144:147], v[44:47]
    ds_read_b128 v[104:107], v80 offset:51200
    v_mfma_f32_16x16x32_bf16 v[48:51], v[156:159], v[132:135], v[48:51]
    ds_read_b128 v[108:111], v80 offset:53248
    v_mfma_f32_16x16x32_bf16 v[52:55], v[156:159], v[136:139], v[52:55]
    ds_read_b128 v[112:115], v80 offset:55296
    v_mfma_f32_16x16x32_bf16 v[56:59], v[156:159], v[140:143], v[56:59]
    ds_read_b64_tr_b16 v[120:121], v83 offset:16384
    v_mfma_f32_16x16x32_bf16 v[60:63], v[156:159], v[144:147], v[60:63]
    ds_read_b64_tr_b16 v[122:123], v83 offset:17408
    v_mfma_f32_16x16x32_bf16 v[64:67], v[160:163], v[132:135], v[64:67]
    ds_read_b64_tr_b16 v[124:125], v84 offset:16384
    v_mfma_f32_16x16x32_bf16 v[68:71], v[160:163], v[136:139], v[68:71]
    ds_read_b64_tr_b16 v[126:127], v84 offset:17408
    v_mfma_f32_16x16x32_bf16 v[72:75], v[160:163], v[140:143], v[72:75]
    ds_read_b64_tr_b16 v[128:129], v85 offset:16384
    v_mfma_f32_16x16x32_bf16 v[76:79], v[160:163], v[144:147], v[76:79]
    ds_read_b64_tr_b16 v[130:131], v85 offset:17408
    s_waitcnt lgkmcnt(6)
    v_mfma_f32_16x16x32_bf16 v[16:19], v[116:119], v[100:103], v[16:19]
    v_mfma_f32_16x16x32_bf16 v[20:23], v[116:119], v[104:107], v[20:23]
    ds_read_b64_tr_b16 v[148:149], v82 offset:24576
    v_mfma_f32_16x16x32_bf16 v[24:27], v[116:119], v[108:111], v[24:27]
    ds_read_b64_tr_b16 v[150:151], v82 offset:25600
    v_mfma_f32_16x16x32_bf16 v[28:31], v[116:119], v[112:115], v[28:31]
    ds_read_b128 v[132:135], v81 offset:49152
    s_waitcnt lgkmcnt(7)
    v_mfma_f32_16x16x32_bf16 v[32:35], v[120:123], v[100:103], v[32:35]
    ds_read_b128 v[136:139], v81 offset:51200
    v_mfma_f32_16x16x32_bf16 v[36:39], v[120:123], v[104:107], v[36:39]
    ds_read_b128 v[140:143], v81 offset:53248
    v_mfma_f32_16x16x32_bf16 v[40:43], v[120:123], v[108:111], v[40:43]
    ds_read_b128 v[144:147], v81 offset:55296
    v_mfma_f32_16x16x32_bf16 v[44:47], v[120:123], v[112:115], v[44:47]
    ds_read_b64_tr_b16 v[152:153], v83 offset:24576
    s_waitcnt lgkmcnt(9)
    v_mfma_f32_16x16x32_bf16 v[48:51], v[124:127], v[100:103], v[48:51]
    ds_read_b64_tr_b16 v[154:155], v83 offset:25600
    v_mfma_f32_16x16x32_bf16 v[52:55], v[124:127], v[104:107], v[52:55]
    ds_read_b64_tr_b16 v[156:157], v84 offset:24576
    v_mfma_f32_16x16x32_bf16 v[56:59], v[124:127], v[108:111], v[56:59]
    ds_read_b64_tr_b16 v[158:159], v84 offset:25600
    v_mfma_f32_16x16x32_bf16 v[60:63], v[124:127], v[112:115], v[60:63]
    ds_read_b64_tr_b16 v[160:161], v85 offset:24576
    s_waitcnt lgkmcnt(11)
    v_mfma_f32_16x16x32_bf16 v[64:67], v[128:131], v[100:103], v[64:67]
    ds_read_b64_tr_b16 v[162:163], v85 offset:25600
    v_mfma_f32_16x16x32_bf16 v[68:71], v[128:131], v[104:107], v[68:71]
    v_mfma_f32_16x16x32_bf16 v[72:75], v[128:131], v[108:111], v[72:75]
    v_mfma_f32_16x16x32_bf16 v[76:79], v[128:131], v[112:115], v[76:79]
    s_waitcnt lgkmcnt(6)
    v_mfma_f32_16x16x32_bf16 v[16:19], v[148:151], v[132:135], v[16:19]
    v_mfma_f32_16x16x32_bf16 v[20:23], v[148:151], v[136:139], v[20:23]
    v_mfma_f32_16x16x32_bf16 v[24:27], v[148:151], v[140:143], v[24:27]
    v_mfma_f32_16x16x32_bf16 v[28:31], v[148:151], v[144:147], v[28:31]
    s_waitcnt lgkmcnt(0)
    s_barrier
    v_mfma_f32_16x16x32_bf16 v[32:35], v[152:155], v[132:135], v[32:35]
    ds_read_b64_tr_b16 v[116:117], v86 offset:0
    v_mfma_f32_16x16x32_bf16 v[36:39], v[152:155], v[136:139], v[36:39]
    ds_read_b64_tr_b16 v[118:119], v86 offset:1024
    v_mfma_f32_16x16x32_bf16 v[40:43], v[152:155], v[140:143], v[40:43]
    ds_read_b128 v[100:103], v80 offset:0
    v_mfma_f32_16x16x32_bf16 v[44:47], v[152:155], v[144:147], v[44:47]
    ds_read_b128 v[104:107], v80 offset:2048
    v_mfma_f32_16x16x32_bf16 v[48:51], v[156:159], v[132:135], v[48:51]
    ds_read_b128 v[108:111], v80 offset:4096
    v_mfma_f32_16x16x32_bf16 v[52:55], v[156:159], v[136:139], v[52:55]
    ds_read_b128 v[112:115], v80 offset:6144
    v_mfma_f32_16x16x32_bf16 v[56:59], v[156:159], v[140:143], v[56:59]
    ds_read_b64_tr_b16 v[120:121], v87 offset:0
    v_mfma_f32_16x16x32_bf16 v[60:63], v[156:159], v[144:147], v[60:63]
    ds_read_b64_tr_b16 v[122:123], v87 offset:1024
    v_mfma_f32_16x16x32_bf16 v[64:67], v[160:163], v[132:135], v[64:67]
    ds_read_b64_tr_b16 v[124:125], v88 offset:0
    v_mfma_f32_16x16x32_bf16 v[68:71], v[160:163], v[136:139], v[68:71]
    ds_read_b64_tr_b16 v[126:127], v88 offset:1024
    v_mfma_f32_16x16x32_bf16 v[72:75], v[160:163], v[140:143], v[72:75]
    ds_read_b64_tr_b16 v[128:129], v89 offset:0
    v_mfma_f32_16x16x32_bf16 v[76:79], v[160:163], v[144:147], v[76:79]
    ds_read_b64_tr_b16 v[130:131], v89 offset:1024
    s_waitcnt lgkmcnt(6)
    v_mfma_f32_16x16x32_bf16 v[16:19], v[116:119], v[100:103], v[16:19]
    v_mfma_f32_16x16x32_bf16 v[20:23], v[116:119], v[104:107], v[20:23]
    ds_read_b64_tr_b16 v[148:149], v86 offset:8192
    v_mfma_f32_16x16x32_bf16 v[24:27], v[116:119], v[108:111], v[24:27]
    ds_read_b64_tr_b16 v[150:151], v86 offset:9216
    v_mfma_f32_16x16x32_bf16 v[28:31], v[116:119], v[112:115], v[28:31]
    ds_read_b128 v[132:135], v81 offset:0
    s_waitcnt lgkmcnt(7)
    v_mfma_f32_16x16x32_bf16 v[32:35], v[120:123], v[100:103], v[32:35]
    ds_read_b128 v[136:139], v81 offset:2048
    v_mfma_f32_16x16x32_bf16 v[36:39], v[120:123], v[104:107], v[36:39]
    ds_read_b128 v[140:143], v81 offset:4096
    v_mfma_f32_16x16x32_bf16 v[40:43], v[120:123], v[108:111], v[40:43]
    ds_read_b128 v[144:147], v81 offset:6144
    v_mfma_f32_16x16x32_bf16 v[44:47], v[120:123], v[112:115], v[44:47]
    ds_read_b64_tr_b16 v[152:153], v87 offset:8192
    s_waitcnt lgkmcnt(9)
    v_mfma_f32_16x16x32_bf16 v[48:51], v[124:127], v[100:103], v[48:51]
    ds_read_b64_tr_b16 v[154:155], v87 offset:9216
    v_mfma_f32_16x16x32_bf16 v[52:55], v[124:127], v[104:107], v[52:55]
    ds_read_b64_tr_b16 v[156:157], v88 offset:8192
    v_mfma_f32_16x16x32_bf16 v[56:59], v[124:127], v[108:111], v[56:59]
    ds_read_b64_tr_b16 v[158:159], v88 offset:9216
    v_mfma_f32_16x16x32_bf16 v[60:63], v[124:127], v[112:115], v[60:63]
    ds_read_b64_tr_b16 v[160:161], v89 offset:8192
    s_waitcnt lgkmcnt(11)
    v_mfma_f32_16x16x32_bf16 v[64:67], v[128:131], v[100:103], v[64:67]
    ds_read_b64_tr_b16 v[162:163], v89 offset:9216
    v_mfma_f32_16x16x32_bf16 v[68:71], v[128:131], v[104:107], v[68:71]
    v_mfma_f32_16x16x32_bf16 v[72:75], v[128:131], v[108:111], v[72:75]
    v_mfma_f32_16x16x32_bf16 v[76:79], v[128:131], v[112:115], v[76:79]
    s_waitcnt lgkmcnt(6)
    v_mfma_f32_16x16x32_bf16 v[16:19], v[148:151], v[132:135], v[16:19]
    v_mfma_f32_16x16x32_bf16 v[20:23], v[148:151], v[136:139], v[20:23]
    s_add_u32 m0, s70, 98304
    s_cmp_le_u32 s43, 0
    s_cselect_b32 s34, s33, s32
    s_add_u32 s34, s34, 28672
    buffer_load_dwordx4 v1, s[12:15], s34 offen lds
    v_mfma_f32_16x16x32_bf16 v[24:27], v[148:151], v[140:143], v[24:27]
    v_mfma_f32_16x16x32_bf16 v[28:31], v[148:151], v[144:147], v[28:31]
    s_waitcnt lgkmcnt(0)
    s_barrier
    v_mfma_f32_16x16x32_bf16 v[32:35], v[152:155], v[132:135], v[32:35]
    ds_read_b64_tr_b16 v[116:117], v82 offset:0
    v_mfma_f32_16x16x32_bf16 v[36:39], v[152:155], v[136:139], v[36:39]
    buffer_load_dwordx4 v2, s[12:15], s34 offen offset:1024 lds
    ds_read_b64_tr_b16 v[118:119], v82 offset:1024
    v_mfma_f32_16x16x32_bf16 v[40:43], v[152:155], v[140:143], v[40:43]
    ds_read_b128 v[100:103], v80 offset:32768
    v_mfma_f32_16x16x32_bf16 v[44:47], v[152:155], v[144:147], v[44:47]
    ds_read_b128 v[104:107], v80 offset:34816
    v_mfma_f32_16x16x32_bf16 v[48:51], v[156:159], v[132:135], v[48:51]
    ds_read_b128 v[108:111], v80 offset:36864
    v_mfma_f32_16x16x32_bf16 v[52:55], v[156:159], v[136:139], v[52:55]
    buffer_load_dwordx4 v3, s[12:15], s34 offen offset:2048 lds
    ds_read_b128 v[112:115], v80 offset:38912
    v_mfma_f32_16x16x32_bf16 v[56:59], v[156:159], v[140:143], v[56:59]
    ds_read_b64_tr_b16 v[120:121], v83 offset:0
    v_mfma_f32_16x16x32_bf16 v[60:63], v[156:159], v[144:147], v[60:63]
    ds_read_b64_tr_b16 v[122:123], v83 offset:1024
    v_mfma_f32_16x16x32_bf16 v[64:67], v[160:163], v[132:135], v[64:67]
    ds_read_b64_tr_b16 v[124:125], v84 offset:0
    v_mfma_f32_16x16x32_bf16 v[68:71], v[160:163], v[136:139], v[68:71]
    buffer_load_dwordx4 v4, s[12:15], s34 offen offset:3072 lds
    ds_read_b64_tr_b16 v[126:127], v84 offset:1024
    v_mfma_f32_16x16x32_bf16 v[72:75], v[160:163], v[140:143], v[72:75]
    ds_read_b64_tr_b16 v[128:129], v85 offset:0
    v_mfma_f32_16x16x32_bf16 v[76:79], v[160:163], v[144:147], v[76:79]
    ds_read_b64_tr_b16 v[130:131], v85 offset:1024
    s_waitcnt lgkmcnt(6)
    v_mfma_f32_16x16x32_bf16 v[16:19], v[116:119], v[100:103], v[16:19]
    v_mfma_f32_16x16x32_bf16 v[20:23], v[116:119], v[104:107], v[20:23]
    s_add_u32 m0, s70, 16384
    s_cmp_le_u32 s43, 1
    s_cselect_b32 s34, s33, s32
    s_add_u32 s34, s34, 114688
    buffer_load_dwordx4 v1, s[12:15], s34 offen lds
    ds_read_b64_tr_b16 v[148:149], v82 offset:8192
    v_mfma_f32_16x16x32_bf16 v[24:27], v[116:119], v[108:111], v[24:27]
    ds_read_b64_tr_b16 v[150:151], v82 offset:9216
    v_mfma_f32_16x16x32_bf16 v[28:31], v[116:119], v[112:115], v[28:31]
    ds_read_b128 v[132:135], v81 offset:32768
    s_waitcnt lgkmcnt(7)
    v_mfma_f32_16x16x32_bf16 v[32:35], v[120:123], v[100:103], v[32:35]
    ds_read_b128 v[136:139], v81 offset:34816
    v_mfma_f32_16x16x32_bf16 v[36:39], v[120:123], v[104:107], v[36:39]
    buffer_load_dwordx4 v2, s[12:15], s34 offen offset:1024 lds
    ds_read_b128 v[140:143], v81 offset:36864
    v_mfma_f32_16x16x32_bf16 v[40:43], v[120:123], v[108:111], v[40:43]
    ds_read_b128 v[144:147], v81 offset:38912
    v_mfma_f32_16x16x32_bf16 v[44:47], v[120:123], v[112:115], v[44:47]
    ds_read_b64_tr_b16 v[152:153], v83 offset:8192
    s_waitcnt lgkmcnt(9)
    v_mfma_f32_16x16x32_bf16 v[48:51], v[124:127], v[100:103], v[48:51]
    ds_read_b64_tr_b16 v[154:155], v83 offset:9216
    v_mfma_f32_16x16x32_bf16 v[52:55], v[124:127], v[104:107], v[52:55]
    buffer_load_dwordx4 v3, s[12:15], s34 offen offset:2048 lds
    ds_read_b64_tr_b16 v[156:157], v84 offset:8192
    v_mfma_f32_16x16x32_bf16 v[56:59], v[124:127], v[108:111], v[56:59]
    ds_read_b64_tr_b16 v[158:159], v84 offset:9216
    v_mfma_f32_16x16x32_bf16 v[60:63], v[124:127], v[112:115], v[60:63]
    ds_read_b64_tr_b16 v[160:161], v85 offset:8192
    s_waitcnt lgkmcnt(11)
    v_mfma_f32_16x16x32_bf16 v[64:67], v[128:131], v[100:103], v[64:67]
    ds_read_b64_tr_b16 v[162:163], v85 offset:9216
    v_mfma_f32_16x16x32_bf16 v[68:71], v[128:131], v[104:107], v[68:71]
    buffer_load_dwordx4 v4, s[12:15], s34 offen offset:3072 lds
    v_mfma_f32_16x16x32_bf16 v[72:75], v[128:131], v[108:111], v[72:75]
    v_mfma_f32_16x16x32_bf16 v[76:79], v[128:131], v[112:115], v[76:79]
    s_waitcnt lgkmcnt(6)
    v_mfma_f32_16x16x32_bf16 v[16:19], v[148:151], v[132:135], v[16:19]
    s_mov_b32 s50, 0xc1700000
    s_mov_b32 s44, 0x38000000
    v_mfma_f32_16x16x32_bf16 v[20:23], v[148:151], v[136:139], v[20:23]
    s_add_u32 m0, s70, 0
    s_cmp_le_u32 s43, 1
    s_cselect_b32 s34, s33, s32
    s_add_u32 s34, s34, 143360
    buffer_load_dwordx4 v1, s[12:15], s34 offen lds
    v_mfma_f32_16x16x32_bf16 v[24:27], v[148:151], v[140:143], v[24:27]
    s_mov_b32 s45, 0x30800000
    s_mov_b32 s71, 0x01000100
    v_mfma_f32_16x16x32_bf16 v[28:31], v[148:151], v[144:147], v[28:31]
    s_waitcnt lgkmcnt(0)
    s_barrier
    ds_read_b32 v168, v91
    v_mfma_f32_16x16x32_bf16 v[32:35], v[152:155], v[132:135], v[32:35]
    ds_read_b64 v[94:95], v92
    v_mfma_f32_16x16x32_bf16 v[36:39], v[152:155], v[136:139], v[36:39]
    buffer_load_dwordx4 v2, s[12:15], s34 offen offset:1024 lds
    ds_read_b32 v164, v90 offset:0
    v_mfma_f32_16x16x32_bf16 v[40:43], v[152:155], v[140:143], v[40:43]
    ds_read_b32 v165, v90 offset:64
    v_mfma_f32_16x16x32_bf16 v[44:47], v[152:155], v[144:147], v[44:47]
    ds_read_b32 v166, v90 offset:384
    v_mfma_f32_16x16x32_bf16 v[48:51], v[156:159], v[132:135], v[48:51]
    ds_read_b32 v167, v90 offset:448
    v_mfma_f32_16x16x32_bf16 v[52:55], v[156:159], v[136:139], v[52:55]
    buffer_load_dwordx4 v3, s[12:15], s34 offen offset:2048 lds
    v_mfma_f32_16x16x32_bf16 v[56:59], v[156:159], v[140:143], v[56:59]
    v_mfma_f32_16x16x32_bf16 v[60:63], v[156:159], v[144:147], v[60:63]
    s_waitcnt lgkmcnt(4)
    v_perm_b32 v96, v168, v168, s71
    v_mfma_f32_16x16x32_bf16 v[64:67], v[160:163], v[132:135], v[64:67]
    v_lshrrev_b32 v97, 16, v168
    v_mfma_f32_16x16x32_bf16 v[68:71], v[160:163], v[136:139], v[68:71]
    buffer_load_dwordx4 v4, s[12:15], s34 offen offset:3072 lds
    v_mfma_f32_16x16x32_bf16 v[72:75], v[160:163], v[140:143], v[72:75]
    s_waitcnt lgkmcnt(0)
    v_and_b32 v164, 0xffff0000, v164
    v_mfma_f32_16x16x32_bf16 v[76:79], v[160:163], v[144:147], v[76:79]
    v_and_b32 v165, 0xffff0000, v165
    v_mfma_f32_16x16x4_4b_bf16 v[16:31], v[94:95], v[96:97], v[16:31] cbsz:2 abid:0
    v_rcp_f32 v232, v164
    v_rcp_f32 v234, v165
    v_and_b32 v166, 0xffff0000, v166
    v_and_b32 v167, 0xffff0000, v167
    v_mfma_f32_16x16x4_4b_bf16 v[32:47], v[94:95], v[96:97], v[32:47] cbsz:2 abid:1
    v_rcp_f32 v236, v166
    v_rcp_f32 v238, v167
    v_mfma_f32_16x16x4_4b_bf16 v[48:63], v[94:95], v[96:97], v[48:63] cbsz:2 abid:2
    v_mul_f32 v233, 0xb1000000, v232
    v_mul_f32 v240, 0x3fb8aa3b, v232
    v_mul_f32 v235, 0xb1000000, v234
    v_mul_f32 v241, 0x3fb8aa3b, v234
    v_mfma_f32_16x16x4_4b_bf16 v[64:79], v[94:95], v[96:97], v[64:79] cbsz:2 abid:3
    v_mul_f32 v237, 0xb1000000, v236
    v_mul_f32 v242, 0x3fb8aa3b, v236
    v_mul_f32 v239, 0xb1000000, v238
    v_mul_f32 v243, 0x3fb8aa3b, v238
    s_branch L_mish
    .p2align 12
L_pad_mish:
    s_branch L_ret_mish
L_mish:
    v_pk_fma_f32 v[248:249], v[16:17], v[240:241], s[50:51] op_sel:[0,0,0] op_sel_hi:[1,0,0]
    v_pk_fma_f32 v[250:251], v[18:19], v[240:241], s[50:51] op_sel:[0,0,0] op_sel_hi:[1,0,0]
    v_pk_fma_f32 v[252:253], v[32:33], v[240:241], s[50:51] op_sel:[0,0,0] op_sel_hi:[1,0,0]
    v_pk_fma_f32 v[254:255], v[34:35], v[240:241], s[50:51] op_sel:[0,0,0] op_sel_hi:[1,0,0]
    v_exp_f32 v248, v248 clamp
    v_exp_f32 v249, v249 clamp
    v_exp_f32 v250, v250 clamp
    v_exp_f32 v251, v251 clamp
    v_exp_f32 v252, v252 clamp
    v_exp_f32 v253, v253 clamp
    v_exp_f32 v254, v254 clamp
    v_exp_f32 v255, v255 clamp
    v_pk_add_f32 v[248:249], v[248:249], s[44:45] op_sel_hi:[1,0]
    v_pk_add_f32 v[250:251], v[250:251], s[44:45] op_sel_hi:[1,0]
    v_pk_add_f32 v[252:253], v[252:253], s[44:45] op_sel_hi:[1,0]
    v_pk_add_f32 v[254:255], v[254:255], s[44:45] op_sel_hi:[1,0]
    v_pk_fma_f32 v[248:249], v[248:249], v[248:249], s[44:45] op_sel:[0,0,1] op_sel_hi:[1,1,1]
    v_pk_fma_f32 v[250:251], v[250:251], v[250:251], s[44:45] op_sel:[0,0,1] op_sel_hi:[1,1,1]
    v_pk_fma_f32 v[252:253], v[252:253], v[252:253], s[44:45] op_sel:[0,0,1] op_sel_hi:[1,1,1]
    v_pk_fma_f32 v[254:255], v[254:255], v[254:255], s[44:45] op_sel:[0,0,1] op_sel_hi:[1,1,1]
    v_pk_mul_f32 v[224:225], v[248:249], v[250:251]
    v_pk_mul_f32 v[226:227], v[252:253], v[254:255]
    v_pk_mul_f32 v[228:229], v[224:225], v[226:227]
    v_rcp_f32 v228, v228
    v_rcp_f32 v229, v229
    s_nop 0
    v_pk_mul_f32 v[228:229], v[228:229], v[232:233] op_sel:[0,1] op_sel_hi:[1,1]
    v_pk_mul_f32 v[226:227], v[226:227], v[228:229]
    v_pk_mul_f32 v[224:225], v[224:225], v[228:229]
    v_pk_fma_f32 v[248:249], v[248:249], v[226:227], v[232:233] op_sel_hi:[1,1,0]
    v_pk_fma_f32 v[250:251], v[250:251], v[226:227], v[232:233] op_sel_hi:[1,1,0]
    v_pk_fma_f32 v[252:253], v[252:253], v[224:225], v[232:233] op_sel_hi:[1,1,0]
    v_pk_fma_f32 v[254:255], v[254:255], v[224:225], v[232:233] op_sel_hi:[1,1,0]
    v_pk_mul_f32 v[248:249], v[248:249], v[18:19]
    v_pk_mul_f32 v[250:251], v[250:251], v[16:17]
    v_pk_mul_f32 v[252:253], v[252:253], v[34:35]
    v_pk_mul_f32 v[254:255], v[254:255], v[32:33]
    v_cvt_pk_bf16_f32 v193, v248, v249
    v_cvt_pk_bf16_f32 v192, v250, v251
    v_cvt_pk_bf16_f32 v195, v252, v253
    v_cvt_pk_bf16_f32 v194, v254, v255
    v_pk_fma_f32 v[248:249], v[20:21], v[240:241], s[50:51] op_sel:[0,1,0] op_sel_hi:[1,1,0]
    v_pk_fma_f32 v[250:251], v[22:23], v[240:241], s[50:51] op_sel:[0,1,0] op_sel_hi:[1,1,0]
    v_pk_fma_f32 v[252:253], v[36:37], v[240:241], s[50:51] op_sel:[0,1,0] op_sel_hi:[1,1,0]
    v_pk_fma_f32 v[254:255], v[38:39], v[240:241], s[50:51] op_sel:[0,1,0] op_sel_hi:[1,1,0]
    v_exp_f32 v248, v248 clamp
    v_exp_f32 v249, v249 clamp
    v_exp_f32 v250, v250 clamp
    v_exp_f32 v251, v251 clamp
    v_exp_f32 v252, v252 clamp
    v_exp_f32 v253, v253 clamp
    v_exp_f32 v254, v254 clamp
    v_exp_f32 v255, v255 clamp
    v_pk_add_f32 v[248:249], v[248:249], s[44:45] op_sel_hi:[1,0]
    v_pk_add_f32 v[250:251], v[250:251], s[44:45] op_sel_hi:[1,0]
    v_pk_add_f32 v[252:253], v[252:253], s[44:45] op_sel_hi:[1,0]
    v_pk_add_f32 v[254:255], v[254:255], s[44:45] op_sel_hi:[1,0]
    v_pk_fma_f32 v[248:249], v[248:249], v[248:249], s[44:45] op_sel:[0,0,1] op_sel_hi:[1,1,1]
    v_pk_fma_f32 v[250:251], v[250:251], v[250:251], s[44:45] op_sel:[0,0,1] op_sel_hi:[1,1,1]
    v_pk_fma_f32 v[252:253], v[252:253], v[252:253], s[44:45] op_sel:[0,0,1] op_sel_hi:[1,1,1]
    v_pk_fma_f32 v[254:255], v[254:255], v[254:255], s[44:45] op_sel:[0,0,1] op_sel_hi:[1,1,1]
    v_pk_mul_f32 v[224:225], v[248:249], v[250:251]
    v_pk_mul_f32 v[226:227], v[252:253], v[254:255]
    v_pk_mul_f32 v[228:229], v[224:225], v[226:227]
    v_rcp_f32 v228, v228
    v_rcp_f32 v229, v229
    s_nop 0
    v_pk_mul_f32 v[228:229], v[228:229], v[234:235] op_sel:[0,1] op_sel_hi:[1,1]
    v_pk_mul_f32 v[226:227], v[226:227], v[228:229]
    v_pk_mul_f32 v[224:225], v[224:225], v[228:229]
    v_pk_fma_f32 v[248:249], v[248:249], v[226:227], v[234:235] op_sel_hi:[1,1,0]
    v_pk_fma_f32 v[250:251], v[250:251], v[226:227], v[234:235] op_sel_hi:[1,1,0]
    v_pk_fma_f32 v[252:253], v[252:253], v[224:225], v[234:235] op_sel_hi:[1,1,0]
    v_pk_fma_f32 v[254:255], v[254:255], v[224:225], v[234:235] op_sel_hi:[1,1,0]
    v_pk_mul_f32 v[248:249], v[248:249], v[22:23]
    v_pk_mul_f32 v[250:251], v[250:251], v[20:21]
    v_pk_mul_f32 v[252:253], v[252:253], v[38:39]
    v_pk_mul_f32 v[254:255], v[254:255], v[36:37]
    v_cvt_pk_bf16_f32 v197, v248, v249
    v_cvt_pk_bf16_f32 v196, v250, v251
    v_cvt_pk_bf16_f32 v199, v252, v253
    v_cvt_pk_bf16_f32 v198, v254, v255
    buffer_store_dwordx4 v[192:195], v9, s[16:19], s30 offen offset:0 sc1
    buffer_store_dwordx4 v[196:199], v9, s[16:19], s30 offen offset:1024 sc1
    v_pk_fma_f32 v[248:249], v[24:25], v[242:243], s[50:51] op_sel:[0,0,0] op_sel_hi:[1,0,0]
    v_pk_fma_f32 v[250:251], v[26:27], v[242:243], s[50:51] op_sel:[0,0,0] op_sel_hi:[1,0,0]
    v_pk_fma_f32 v[252:253], v[40:41], v[242:243], s[50:51] op_sel:[0,0,0] op_sel_hi:[1,0,0]
    v_pk_fma_f32 v[254:255], v[42:43], v[242:243], s[50:51] op_sel:[0,0,0] op_sel_hi:[1,0,0]
    v_exp_f32 v248, v248 clamp
    v_exp_f32 v249, v249 clamp
    v_exp_f32 v250, v250 clamp
    v_exp_f32 v251, v251 clamp
    v_exp_f32 v252, v252 clamp
    v_exp_f32 v253, v253 clamp
    v_exp_f32 v254, v254 clamp
    v_exp_f32 v255, v255 clamp
    v_pk_add_f32 v[248:249], v[248:249], s[44:45] op_sel_hi:[1,0]
    v_pk_add_f32 v[250:251], v[250:251], s[44:45] op_sel_hi:[1,0]
    v_pk_add_f32 v[252:253], v[252:253], s[44:45] op_sel_hi:[1,0]
    v_pk_add_f32 v[254:255], v[254:255], s[44:45] op_sel_hi:[1,0]
    v_pk_fma_f32 v[248:249], v[248:249], v[248:249], s[44:45] op_sel:[0,0,1] op_sel_hi:[1,1,1]
    v_pk_fma_f32 v[250:251], v[250:251], v[250:251], s[44:45] op_sel:[0,0,1] op_sel_hi:[1,1,1]
    v_pk_fma_f32 v[252:253], v[252:253], v[252:253], s[44:45] op_sel:[0,0,1] op_sel_hi:[1,1,1]
    v_pk_fma_f32 v[254:255], v[254:255], v[254:255], s[44:45] op_sel:[0,0,1] op_sel_hi:[1,1,1]
    v_pk_mul_f32 v[224:225], v[248:249], v[250:251]
    v_pk_mul_f32 v[226:227], v[252:253], v[254:255]
    v_pk_mul_f32 v[228:229], v[224:225], v[226:227]
    v_rcp_f32 v228, v228
    v_rcp_f32 v229, v229
    s_nop 0
    v_pk_mul_f32 v[228:229], v[228:229], v[236:237] op_sel:[0,1] op_sel_hi:[1,1]
    v_pk_mul_f32 v[226:227], v[226:227], v[228:229]
    v_pk_mul_f32 v[224:225], v[224:225], v[228:229]
    v_pk_fma_f32 v[248:249], v[248:249], v[226:227], v[236:237] op_sel_hi:[1,1,0]
    v_pk_fma_f32 v[250:251], v[250:251], v[226:227], v[236:237] op_sel_hi:[1,1,0]
    v_pk_fma_f32 v[252:253], v[252:253], v[224:225], v[236:237] op_sel_hi:[1,1,0]
    v_pk_fma_f32 v[254:255], v[254:255], v[224:225], v[236:237] op_sel_hi:[1,1,0]
    v_pk_mul_f32 v[248:249], v[248:249], v[26:27]
    v_pk_mul_f32 v[250:251], v[250:251], v[24:25]
    v_pk_mul_f32 v[252:253], v[252:253], v[42:43]
    v_pk_mul_f32 v[254:255], v[254:255], v[40:41]
    v_cvt_pk_bf16_f32 v201, v248, v249
    v_cvt_pk_bf16_f32 v200, v250, v251
    v_cvt_pk_bf16_f32 v203, v252, v253
    v_cvt_pk_bf16_f32 v202, v254, v255
    buffer_store_dwordx4 v[200:203], v9, s[16:19], s30 offen offset:2048 sc1
    v_pk_fma_f32 v[248:249], v[28:29], v[242:243], s[50:51] op_sel:[0,1,0] op_sel_hi:[1,1,0]
    v_pk_fma_f32 v[250:251], v[30:31], v[242:243], s[50:51] op_sel:[0,1,0] op_sel_hi:[1,1,0]
    v_pk_fma_f32 v[252:253], v[44:45], v[242:243], s[50:51] op_sel:[0,1,0] op_sel_hi:[1,1,0]
    v_pk_fma_f32 v[254:255], v[46:47], v[242:243], s[50:51] op_sel:[0,1,0] op_sel_hi:[1,1,0]
    v_exp_f32 v248, v248 clamp
    v_exp_f32 v249, v249 clamp
    v_exp_f32 v250, v250 clamp
    v_exp_f32 v251, v251 clamp
    v_exp_f32 v252, v252 clamp
    v_exp_f32 v253, v253 clamp
    v_exp_f32 v254, v254 clamp
    v_exp_f32 v255, v255 clamp
    v_pk_add_f32 v[248:249], v[248:249], s[44:45] op_sel_hi:[1,0]
    v_pk_add_f32 v[250:251], v[250:251], s[44:45] op_sel_hi:[1,0]
    v_pk_add_f32 v[252:253], v[252:253], s[44:45] op_sel_hi:[1,0]
    v_pk_add_f32 v[254:255], v[254:255], s[44:45] op_sel_hi:[1,0]
    v_pk_fma_f32 v[248:249], v[248:249], v[248:249], s[44:45] op_sel:[0,0,1] op_sel_hi:[1,1,1]
    v_pk_fma_f32 v[250:251], v[250:251], v[250:251], s[44:45] op_sel:[0,0,1] op_sel_hi:[1,1,1]
    v_pk_fma_f32 v[252:253], v[252:253], v[252:253], s[44:45] op_sel:[0,0,1] op_sel_hi:[1,1,1]
    v_pk_fma_f32 v[254:255], v[254:255], v[254:255], s[44:45] op_sel:[0,0,1] op_sel_hi:[1,1,1]
    v_pk_mul_f32 v[224:225], v[248:249], v[250:251]
    v_pk_mul_f32 v[226:227], v[252:253], v[254:255]
    v_pk_mul_f32 v[228:229], v[224:225], v[226:227]
    v_rcp_f32 v228, v228
    v_rcp_f32 v229, v229
    s_nop 0
    v_pk_mul_f32 v[228:229], v[228:229], v[238:239] op_sel:[0,1] op_sel_hi:[1,1]
    v_pk_mul_f32 v[226:227], v[226:227], v[228:229]
    v_pk_mul_f32 v[224:225], v[224:225], v[228:229]
    v_pk_fma_f32 v[248:249], v[248:249], v[226:227], v[238:239] op_sel_hi:[1,1,0]
    v_pk_fma_f32 v[250:251], v[250:251], v[226:227], v[238:239] op_sel_hi:[1,1,0]
    v_pk_fma_f32 v[252:253], v[252:253], v[224:225], v[238:239] op_sel_hi:[1,1,0]
    v_pk_fma_f32 v[254:255], v[254:255], v[224:225], v[238:239] op_sel_hi:[1,1,0]
    v_pk_mul_f32 v[248:249], v[248:249], v[30:31]
    v_pk_mul_f32 v[250:251], v[250:251], v[28:29]
    v_pk_mul_f32 v[252:253], v[252:253], v[46:47]
    v_pk_mul_f32 v[254:255], v[254:255], v[44:45]
    v_cvt_pk_bf16_f32 v205, v248, v249
    v_cvt_pk_bf16_f32 v204, v250, v251
    v_cvt_pk_bf16_f32 v207, v252, v253
    v_cvt_pk_bf16_f32 v206, v254, v255
    buffer_store_dwordx4 v[204:207], v9, s[16:19], s30 offen offset:3072 sc1
    v_pk_fma_f32 v[248:249], v[48:49], v[240:241], s[50:51] op_sel:[0,0,0] op_sel_hi:[1,0,0]
    v_pk_fma_f32 v[250:251], v[50:51], v[240:241], s[50:51] op_sel:[0,0,0] op_sel_hi:[1,0,0]
    v_pk_fma_f32 v[252:253], v[64:65], v[240:241], s[50:51] op_sel:[0,0,0] op_sel_hi:[1,0,0]
    v_pk_fma_f32 v[254:255], v[66:67], v[240:241], s[50:51] op_sel:[0,0,0] op_sel_hi:[1,0,0]
    v_exp_f32 v248, v248 clamp
    v_exp_f32 v249, v249 clamp
    v_exp_f32 v250, v250 clamp
    v_exp_f32 v251, v251 clamp
    v_exp_f32 v252, v252 clamp
    v_exp_f32 v253, v253 clamp
    v_exp_f32 v254, v254 clamp
    v_exp_f32 v255, v255 clamp
    v_pk_add_f32 v[248:249], v[248:249], s[44:45] op_sel_hi:[1,0]
    v_pk_add_f32 v[250:251], v[250:251], s[44:45] op_sel_hi:[1,0]
    v_pk_add_f32 v[252:253], v[252:253], s[44:45] op_sel_hi:[1,0]
    v_pk_add_f32 v[254:255], v[254:255], s[44:45] op_sel_hi:[1,0]
    v_pk_fma_f32 v[248:249], v[248:249], v[248:249], s[44:45] op_sel:[0,0,1] op_sel_hi:[1,1,1]
    v_pk_fma_f32 v[250:251], v[250:251], v[250:251], s[44:45] op_sel:[0,0,1] op_sel_hi:[1,1,1]
    v_pk_fma_f32 v[252:253], v[252:253], v[252:253], s[44:45] op_sel:[0,0,1] op_sel_hi:[1,1,1]
    v_pk_fma_f32 v[254:255], v[254:255], v[254:255], s[44:45] op_sel:[0,0,1] op_sel_hi:[1,1,1]
    v_pk_mul_f32 v[224:225], v[248:249], v[250:251]
    v_pk_mul_f32 v[226:227], v[252:253], v[254:255]
    v_pk_mul_f32 v[228:229], v[224:225], v[226:227]
    v_rcp_f32 v228, v228
    v_rcp_f32 v229, v229
    s_nop 0
    v_pk_mul_f32 v[228:229], v[228:229], v[232:233] op_sel:[0,1] op_sel_hi:[1,1]
    v_pk_mul_f32 v[226:227], v[226:227], v[228:229]
    v_pk_mul_f32 v[224:225], v[224:225], v[228:229]
    v_pk_fma_f32 v[248:249], v[248:249], v[226:227], v[232:233] op_sel_hi:[1,1,0]
    v_pk_fma_f32 v[250:251], v[250:251], v[226:227], v[232:233] op_sel_hi:[1,1,0]
    v_pk_fma_f32 v[252:253], v[252:253], v[224:225], v[232:233] op_sel_hi:[1,1,0]
    v_pk_fma_f32 v[254:255], v[254:255], v[224:225], v[232:233] op_sel_hi:[1,1,0]
    v_pk_mul_f32 v[248:249], v[248:249], v[50:51]
    v_pk_mul_f32 v[250:251], v[250:251], v[48:49]
    v_pk_mul_f32 v[252:253], v[252:253], v[66:67]
    v_pk_mul_f32 v[254:255], v[254:255], v[64:65]
    v_cvt_pk_bf16_f32 v209, v248, v249
    v_cvt_pk_bf16_f32 v208, v250, v251
    v_cvt_pk_bf16_f32 v211, v252, v253
    v_cvt_pk_bf16_f32 v210, v254, v255
    buffer_store_dwordx4 v[208:211], v9, s[16:19], s39 offen offset:0 sc1
    v_pk_fma_f32 v[248:249], v[52:53], v[240:241], s[50:51] op_sel:[0,1,0] op_sel_hi:[1,1,0]
    v_pk_fma_f32 v[250:251], v[54:55], v[240:241], s[50:51] op_sel:[0,1,0] op_sel_hi:[1,1,0]
    v_pk_fma_f32 v[252:253], v[68:69], v[240:241], s[50:51] op_sel:[0,1,0] op_sel_hi:[1,1,0]
    v_pk_fma_f32 v[254:255], v[70:71], v[240:241], s[50:51] op_sel:[0,1,0] op_sel_hi:[1,1,0]
    v_exp_f32 v248, v248 clamp
    v_exp_f32 v249, v249 clamp
    v_exp_f32 v250, v250 clamp
    v_exp_f32 v251, v251 clamp
    v_exp_f32 v252, v252 clamp
    v_exp_f32 v253, v253 clamp
    v_exp_f32 v254, v254 clamp
    v_exp_f32 v255, v255 clamp
    v_pk_add_f32 v[248:249], v[248:249], s[44:45] op_sel_hi:[1,0]
    v_pk_add_f32 v[250:251], v[250:251], s[44:45] op_sel_hi:[1,0]
    v_pk_add_f32 v[252:253], v[252:253], s[44:45] op_sel_hi:[1,0]
    v_pk_add_f32 v[254:255], v[254:255], s[44:45] op_sel_hi:[1,0]
    v_pk_fma_f32 v[248:249], v[248:249], v[248:249], s[44:45] op_sel:[0,0,1] op_sel_hi:[1,1,1]
    v_pk_fma_f32 v[250:251], v[250:251], v[250:251], s[44:45] op_sel:[0,0,1] op_sel_hi:[1,1,1]
    v_pk_fma_f32 v[252:253], v[252:253], v[252:253], s[44:45] op_sel:[0,0,1] op_sel_hi:[1,1,1]
    v_pk_fma_f32 v[254:255], v[254:255], v[254:255], s[44:45] op_sel:[0,0,1] op_sel_hi:[1,1,1]
    v_pk_mul_f32 v[224:225], v[248:249], v[250:251]
    v_pk_mul_f32 v[226:227], v[252:253], v[254:255]
    v_pk_mul_f32 v[228:229], v[224:225], v[226:227]
    v_rcp_f32 v228, v228
    v_rcp_f32 v229, v229
    s_nop 0
    v_pk_mul_f32 v[228:229], v[228:229], v[234:235] op_sel:[0,1] op_sel_hi:[1,1]
    v_pk_mul_f32 v[226:227], v[226:227], v[228:229]
    v_pk_mul_f32 v[224:225], v[224:225], v[228:229]
    v_pk_fma_f32 v[248:249], v[248:249], v[226:227], v[234:235] op_sel_hi:[1,1,0]
    v_pk_fma_f32 v[250:251], v[250:251], v[226:227], v[234:235] op_sel_hi:[1,1,0]
    v_pk_fma_f32 v[252:253], v[252:253], v[224:225], v[234:235] op_sel_hi:[1,1,0]
    v_pk_fma_f32 v[254:255], v[254:255], v[224:225], v[234:235] op_sel_hi:[1,1,0]
    v_pk_mul_f32 v[248:249], v[248:249], v[54:55]
    v_pk_mul_f32 v[250:251], v[250:251], v[52:53]
    v_pk_mul_f32 v[252:253], v[252:253], v[70:71]
    v_pk_mul_f32 v[254:255], v[254:255], v[68:69]
    v_cvt_pk_bf16_f32 v213, v248, v249
    v_cvt_pk_bf16_f32 v212, v250, v251
    v_cvt_pk_bf16_f32 v215, v252, v253
    v_cvt_pk_bf16_f32 v214, v254, v255
    buffer_store_dwordx4 v[212:215], v9, s[16:19], s39 offen offset:1024 sc1
    v_pk_fma_f32 v[248:249], v[56:57], v[242:243], s[50:51] op_sel:[0,0,0] op_sel_hi:[1,0,0]
    v_pk_fma_f32 v[250:251], v[58:59], v[242:243], s[50:51] op_sel:[0,0,0] op_sel_hi:[1,0,0]
    v_pk_fma_f32 v[252:253], v[72:73], v[242:243], s[50:51] op_sel:[0,0,0] op_sel_hi:[1,0,0]
    v_pk_fma_f32 v[254:255], v[74:75], v[242:243], s[50:51] op_sel:[0,0,0] op_sel_hi:[1,0,0]
    v_exp_f32 v248, v248 clamp
    v_exp_f32 v249, v249 clamp
    v_exp_f32 v250, v250 clamp
    v_exp_f32 v251, v251 clamp
    v_exp_f32 v252, v252 clamp
    v_exp_f32 v253, v253 clamp
    v_exp_f32 v254, v254 clamp
    v_exp_f32 v255, v255 clamp
    v_pk_add_f32 v[248:249], v[248:249], s[44:45] op_sel_hi:[1,0]
    v_pk_add_f32 v[250:251], v[250:251], s[44:45] op_sel_hi:[1,0]
    v_pk_add_f32 v[252:253], v[252:253], s[44:45] op_sel_hi:[1,0]
    v_pk_add_f32 v[254:255], v[254:255], s[44:45] op_sel_hi:[1,0]
    v_pk_fma_f32 v[248:249], v[248:249], v[248:249], s[44:45] op_sel:[0,0,1] op_sel_hi:[1,1,1]
    v_pk_fma_f32 v[250:251], v[250:251], v[250:251], s[44:45] op_sel:[0,0,1] op_sel_hi:[1,1,1]
    v_pk_fma_f32 v[252:253], v[252:253], v[252:253], s[44:45] op_sel:[0,0,1] op_sel_hi:[1,1,1]
    v_pk_fma_f32 v[254:255], v[254:255], v[254:255], s[44:45] op_sel:[0,0,1] op_sel_hi:[1,1,1]
    v_pk_mul_f32 v[224:225], v[248:249], v[250:251]
    v_pk_mul_f32 v[226:227], v[252:253], v[254:255]
    v_pk_mul_f32 v[228:229], v[224:225], v[226:227]
    v_rcp_f32 v228, v228
    v_rcp_f32 v229, v229
    s_nop 0
    v_pk_mul_f32 v[228:229], v[228:229], v[236:237] op_sel:[0,1] op_sel_hi:[1,1]
    v_pk_mul_f32 v[226:227], v[226:227], v[228:229]
    v_pk_mul_f32 v[224:225], v[224:225], v[228:229]
    v_pk_fma_f32 v[248:249], v[248:249], v[226:227], v[236:237] op_sel_hi:[1,1,0]
    v_pk_fma_f32 v[250:251], v[250:251], v[226:227], v[236:237] op_sel_hi:[1,1,0]
    v_pk_fma_f32 v[252:253], v[252:253], v[224:225], v[236:237] op_sel_hi:[1,1,0]
    v_pk_fma_f32 v[254:255], v[254:255], v[224:225], v[236:237] op_sel_hi:[1,1,0]
    v_pk_mul_f32 v[248:249], v[248:249], v[58:59]
    v_pk_mul_f32 v[250:251], v[250:251], v[56:57]
    v_pk_mul_f32 v[252:253], v[252:253], v[74:75]
    v_pk_mul_f32 v[254:255], v[254:255], v[72:73]
    v_cvt_pk_bf16_f32 v217, v248, v249
    v_cvt_pk_bf16_f32 v216, v250, v251
    v_cvt_pk_bf16_f32 v219, v252, v253
    v_cvt_pk_bf16_f32 v218, v254, v255
    buffer_store_dwordx4 v[216:219], v9, s[16:19], s39 offen offset:2048 sc1
    v_pk_fma_f32 v[248:249], v[60:61], v[242:243], s[50:51] op_sel:[0,1,0] op_sel_hi:[1,1,0]
    v_pk_fma_f32 v[250:251], v[62:63], v[242:243], s[50:51] op_sel:[0,1,0] op_sel_hi:[1,1,0]
    v_pk_fma_f32 v[252:253], v[76:77], v[242:243], s[50:51] op_sel:[0,1,0] op_sel_hi:[1,1,0]
    v_pk_fma_f32 v[254:255], v[78:79], v[242:243], s[50:51] op_sel:[0,1,0] op_sel_hi:[1,1,0]
    v_exp_f32 v248, v248 clamp
    v_exp_f32 v249, v249 clamp
    v_exp_f32 v250, v250 clamp
    v_exp_f32 v251, v251 clamp
    v_exp_f32 v252, v252 clamp
    v_exp_f32 v253, v253 clamp
    v_exp_f32 v254, v254 clamp
    v_exp_f32 v255, v255 clamp
    v_pk_add_f32 v[248:249], v[248:249], s[44:45] op_sel_hi:[1,0]
    v_pk_add_f32 v[250:251], v[250:251], s[44:45] op_sel_hi:[1,0]
    v_pk_add_f32 v[252:253], v[252:253], s[44:45] op_sel_hi:[1,0]
    v_pk_add_f32 v[254:255], v[254:255], s[44:45] op_sel_hi:[1,0]
    v_pk_fma_f32 v[248:249], v[248:249], v[248:249], s[44:45] op_sel:[0,0,1] op_sel_hi:[1,1,1]
    v_pk_fma_f32 v[250:251], v[250:251], v[250:251], s[44:45] op_sel:[0,0,1] op_sel_hi:[1,1,1]
    v_pk_fma_f32 v[252:253], v[252:253], v[252:253], s[44:45] op_sel:[0,0,1] op_sel_hi:[1,1,1]
    v_pk_fma_f32 v[254:255], v[254:255], v[254:255], s[44:45] op_sel:[0,0,1] op_sel_hi:[1,1,1]
    v_pk_mul_f32 v[224:225], v[248:249], v[250:251]
    v_pk_mul_f32 v[226:227], v[252:253], v[254:255]
    v_pk_mul_f32 v[228:229], v[224:225], v[226:227]
    v_rcp_f32 v228, v228
    v_rcp_f32 v229, v229
    s_nop 0
    v_pk_mul_f32 v[228:229], v[228:229], v[238:239] op_sel:[0,1] op_sel_hi:[1,1]
    v_pk_mul_f32 v[226:227], v[226:227], v[228:229]
    v_pk_mul_f32 v[224:225], v[224:225], v[228:229]
    v_pk_fma_f32 v[248:249], v[248:249], v[226:227], v[238:239] op_sel_hi:[1,1,0]
    v_pk_fma_f32 v[250:251], v[250:251], v[226:227], v[238:239] op_sel_hi:[1,1,0]
    v_pk_fma_f32 v[252:253], v[252:253], v[224:225], v[238:239] op_sel_hi:[1,1,0]
    v_pk_fma_f32 v[254:255], v[254:255], v[224:225], v[238:239] op_sel_hi:[1,1,0]
    v_pk_mul_f32 v[248:249], v[248:249], v[62:63]
    v_pk_mul_f32 v[250:251], v[250:251], v[60:61]
    v_pk_mul_f32 v[252:253], v[252:253], v[78:79]
    v_pk_mul_f32 v[254:255], v[254:255], v[76:77]
    s_barrier
    v_cvt_pk_bf16_f32 v221, v248, v249
    v_cvt_pk_bf16_f32 v220, v250, v251
    v_cvt_pk_bf16_f32 v223, v252, v253
    v_cvt_pk_bf16_f32 v222, v254, v255
    buffer_store_dwordx4 v[220:223], v9, s[16:19], s39 offen offset:3072 sc1
    s_setprio 3
    s_waitcnt vmcnt(8)
    v_add_u32 v240, 65536, v5
    v_add_u32 v241, 65536, v6
    v_add_u32 v242, 65536, v7
    v_add_u32 v243, 65536, v8
    s_lshl_b32 s36, s64, 1
    s_and_b32 s71, s60, 1
    s_add_u32 s36, s36, s71
    s_lshl_b32 s37, s36, 2
    s_add_u32 s37, s37, s3
    s_lshl_b32 s37, s37, 9
    s_add_u32 s37, s37, 65536
    s_add_u32 s48, s58, s37
    s_addc_u32 s49, s59, 0
    s_add_u32 m0, s70, 32768
    s_cmp_le_u32 s43, 2
    s_cselect_b32 s34, s33, s32
    s_add_u32 s34, s34, 229376
    buffer_load_dwordx4 v1, s[12:15], s34 offen lds
    ds_read_b64_tr_b16 v[80:81], v5 offset:49152
    ds_read_b64_tr_b16 v[82:83], v5 offset:51200
    ds_read_b64_tr_b16 v[84:85], v6 offset:49152
    ds_read_b64_tr_b16 v[86:87], v6 offset:51200
    buffer_load_dwordx4 v2, s[12:15], s34 offen offset:1024 lds
    ds_read_b64_tr_b16 v[88:89], v7 offset:49152
    ds_read_b64_tr_b16 v[90:91], v7 offset:51200
    ds_read_b64_tr_b16 v[92:93], v8 offset:49152
    ds_read_b64_tr_b16 v[94:95], v8 offset:51200
    buffer_load_dwordx4 v3, s[12:15], s34 offen offset:2048 lds
    ds_read_b64_tr_b16 v[96:97], v240 offset:16384
    ds_read_b64_tr_b16 v[98:99], v240 offset:18432
    ds_read_b64_tr_b16 v[100:101], v241 offset:16384
    ds_read_b64_tr_b16 v[102:103], v241 offset:18432
    buffer_load_dwordx4 v4, s[12:15], s34 offen offset:3072 lds
    ds_read_b64_tr_b16 v[104:105], v242 offset:16384
    ds_read_b64_tr_b16 v[106:107], v242 offset:18432
    ds_read_b64_tr_b16 v[108:109], v243 offset:16384
    ds_read_b64_tr_b16 v[110:111], v243 offset:18432
    s_waitcnt lgkmcnt(8)
    s_add_u32 m0, s70, 49152
    s_cmp_le_u32 s43, 2
    s_cselect_b32 s34, s33, s32
    s_add_u32 s34, s34, 258048
    buffer_load_dwordx4 v1, s[12:15], s34 offen lds
    ds_read_b64_tr_b16 v[112:113], v240 offset:0
    ds_read_b64_tr_b16 v[114:115], v240 offset:2048
    ds_read_b64_tr_b16 v[116:117], v241 offset:0
    buffer_load_dwordx4 v2, s[12:15], s34 offen offset:1024 lds
    ds_read_b64_tr_b16 v[118:119], v241 offset:2048
    ds_read_b64_tr_b16 v[120:121], v242 offset:0
    ds_read_b64_tr_b16 v[122:123], v242 offset:2048
    buffer_load_dwordx4 v3, s[12:15], s34 offen offset:2048 lds
    ds_read_b64_tr_b16 v[124:125], v243 offset:0
    ds_read_b64_tr_b16 v[126:127], v243 offset:2048
    ds_read_b64_tr_b16 v[128:129], v240 offset:32768
    buffer_load_dwordx4 v4, s[12:15], s34 offen offset:3072 lds
    ds_read_b64_tr_b16 v[130:131], v240 offset:34816
    ds_read_b64_tr_b16 v[132:133], v241 offset:32768
    ds_read_b64_tr_b16 v[134:135], v241 offset:34816
    s_waitcnt vmcnt(8)
    s_mov_b32 s72, 1
    s_atomic_add s72, s[58:59], s31
    s_waitcnt lgkmcnt(12)
    s_add_u32 m0, s70, 81920
    s_cmp_le_u32 s43, 3
    s_cselect_b32 s34, s33, s32
    s_add_u32 s34, s34, 344064
    buffer_load_dwordx4 v1, s[12:15], s34 offen lds
    ds_read_b64_tr_b16 v[136:137], v242 offset:32768
    ds_read_b64_tr_b16 v[138:139], v242 offset:34816
    ds_read_b64_tr_b16 v[140:141], v243 offset:32768
    buffer_load_dwordx4 v2, s[12:15], s34 offen offset:1024 lds
    ds_read_b64_tr_b16 v[142:143], v243 offset:34816
    ds_read_b64_tr_b16 v[144:145], v5 offset:16384
    ds_read_b64_tr_b16 v[146:147], v5 offset:18432
    buffer_load_dwordx4 v3, s[12:15], s34 offen offset:2048 lds
    ds_read_b64_tr_b16 v[148:149], v6 offset:16384
    ds_read_b64_tr_b16 v[150:151], v6 offset:18432
    ds_read_b64_tr_b16 v[152:153], v7 offset:16384
    buffer_load_dwordx4 v4, s[12:15], s34 offen offset:3072 lds
    ds_read_b64_tr_b16 v[154:155], v7 offset:18432
    ds_read_b64_tr_b16 v[156:157], v8 offset:16384
    ds_read_b64_tr_b16 v[158:159], v8 offset:18432
    s_waitcnt lgkmcnt(15)
    s_add_u32 m0, s70, 65536
    s_cmp_le_u32 s43, 3
    s_cselect_b32 s34, s33, s32
    s_add_u32 s34, s34, 372736
    buffer_load_dwordx4 v1, s[12:15], s34 offen lds
    ds_read_b64_tr_b16 v[160:161], v5 offset:0
    ds_read_b64_tr_b16 v[162:163], v5 offset:2048
    ds_read_b64_tr_b16 v[164:165], v6 offset:0
    buffer_load_dwordx4 v2, s[12:15], s34 offen offset:1024 lds
    ds_read_b64_tr_b16 v[166:167], v6 offset:2048
    ds_read_b64_tr_b16 v[168:169], v7 offset:0
    ds_read_b64_tr_b16 v[170:171], v7 offset:2048
    buffer_load_dwordx4 v3, s[12:15], s34 offen offset:2048 lds
    ds_read_b64_tr_b16 v[172:173], v8 offset:0
    ds_read_b64_tr_b16 v[174:175], v8 offset:2048
    buffer_load_dwordx4 v4, s[12:15], s34 offen offset:3072 lds
    s_waitcnt vmcnt(12)
    s_waitcnt lgkmcnt(15)
    s_add_u32 m0, s70, 98304
    s_cmp_le_u32 s43, 4
    s_cselect_b32 s34, s33, s32
    s_add_u32 s34, s34, 458752
    buffer_load_dwordx4 v1, s[12:15], s34 offen lds
    ds_read_b64_tr_b16 v[176:177], v5 offset:32768
    ds_read_b64_tr_b16 v[178:179], v5 offset:34816
    ds_read_b64_tr_b16 v[180:181], v6 offset:32768
    buffer_load_dwordx4 v2, s[12:15], s34 offen offset:1024 lds
    ds_read_b64_tr_b16 v[182:183], v6 offset:34816
    ds_read_b64_tr_b16 v[184:185], v7 offset:32768
    ds_read_b64_tr_b16 v[186:187], v7 offset:34816
    buffer_load_dwordx4 v3, s[12:15], s34 offen offset:2048 lds
    ds_read_b64_tr_b16 v[188:189], v8 offset:32768
    ds_read_b64_tr_b16 v[190:191], v8 offset:34816
    buffer_load_dwordx4 v4, s[12:15], s34 offen offset:3072 lds
    ds_read_b32 v11, v12
    s_waitcnt lgkmcnt(1)
    s_add_u32 m0, s70, 16384
    s_cmp_le_u32 s43, 4
    s_cselect_b32 s34, s33, s32
    s_add_u32 s34, s34, 487424
    buffer_load_dwordx4 v1, s[12:15], s34 offen lds
    buffer_load_dwordx4 v2, s[12:15], s34 offen offset:1024 lds
    s_load_dword s52, s[48:49], 0 glc
    s_load_dword s53, s[48:49], 128 glc
    s_load_dword s54, s[48:49], 256 glc
    s_load_dword s55, s[48:49], 384 glc
    buffer_load_dwordx4 v3, s[12:15], s34 offen offset:2048 lds
    buffer_load_dwordx4 v4, s[12:15], s34 offen offset:3072 lds
    s_add_u32 m0, s70, 0
    s_cmp_le_u32 s43, 5
    s_cselect_b32 s34, s33, s32
    s_add_u32 s34, s34, 573440
    buffer_load_dwordx4 v1, s[12:15], s34 offen lds
    buffer_load_dwordx4 v2, s[12:15], s34 offen offset:1024 lds
    buffer_load_dwordx4 v3, s[12:15], s34 offen offset:2048 lds
    buffer_load_dwordx4 v4, s[12:15], s34 offen offset:3072 lds
    s_add_u32 m0, s70, 32768
    s_cmp_le_u32 s43, 5
    s_cselect_b32 s34, s33, s32
    s_add_u32 s34, s34, 602112
    buffer_load_dwordx4 v1, s[12:15], s34 offen lds
    buffer_load_dwordx4 v2, s[12:15], s34 offen offset:1024 lds
    buffer_load_dwordx4 v3, s[12:15], s34 offen offset:2048 lds
    buffer_load_dwordx4 v4, s[12:15], s34 offen offset:3072 lds
    s_and_b32 s71, s3, 1
    s_mul_i32 s71, s71, 14
    s_add_u32 s71, s71, s68
    s_lshl_b32 s71, s71, 13
    s_mul_i32 s32, s36, 229376
    s_add_u32 s32, s32, s71
    s_add_u32 s32, s32, 5242880
    s_add_u32 s33, s32, 16384
    s_mul_i32 s42, s43, 16384
    s_add_u32 s42, s42, s32
    s_branch L_g2
    .p2align 12
L_pad_g2:
L_g2:
    s_mov_b32 s73, 0
L_ap_13:
    s_waitcnt lgkmcnt(0)
    s_add_u32 s52, s52, s53
    s_add_u32 s52, s52, s54
    s_add_u32 s52, s52, s55
    s_add_u32 s73, s73, 1
    s_cmp_ge_u32 s52, 7
    s_cbranch_scc1 L_ar_14
    s_cmp_gt_u32 s73, 1000000
    s_cbranch_scc1 L_ar_14
    s_sleep 1
    s_load_dword s52, s[48:49], 0 glc
    s_load_dword s53, s[48:49], 128 glc
    s_load_dword s54, s[48:49], 256 glc
    s_load_dword s55, s[48:49], 384 glc
    s_branch L_ap_13
L_ar_14:
    s_setprio 0
    s_xor_b32 s71, s3, s60
    s_bitcmp0_b32 s71, 0
    s_cbranch_scc1 L_own_15
    s_add_u32 s71, s42, 0
    buffer_load_dwordx4 v[192:195], v9, s[16:19], s71 offen offset:0 sc1
    buffer_load_dwordx4 v[196:199], v9, s[16:19], s71 offen offset:1024 sc1
    buffer_load_dwordx4 v[200:203], v9, s[16:19], s71 offen offset:2048 sc1
    buffer_load_dwordx4 v[204:207], v9, s[16:19], s71 offen offset:3072 sc1
    s_add_u32 s71, s42, 4096
    buffer_load_dwordx4 v[208:211], v9, s[16:19], s71 offen offset:0 sc1
    buffer_load_dwordx4 v[212:215], v9, s[16:19], s71 offen offset:1024 sc1
    buffer_load_dwordx4 v[216:219], v9, s[16:19], s71 offen offset:2048 sc1
    buffer_load_dwordx4 v[220:223], v9, s[16:19], s71 offen offset:3072 sc1
L_own_15:
    s_cmp_le_u32 s43, 0
    s_cselect_b32 s71, s33, s32
    s_add_u32 s71, s71, 0
    buffer_load_dwordx4 v[224:227], v9, s[16:19], s71 offen offset:0 sc1
    buffer_load_dwordx4 v[228:231], v9, s[16:19], s71 offen offset:1024 sc1
    buffer_load_dwordx4 v[232:235], v9, s[16:19], s71 offen offset:2048 sc1
    buffer_load_dwordx4 v[236:239], v9, s[16:19], s71 offen offset:3072 sc1
    v_and_b32 v14, 15, v0
    v_lshrrev_b32 v15, 4, v0
    v_xor_b32 v15, v15, v14
    v_lshlrev_b32 v15, 4, v15
    v_lshl_add_u32 v15, v14, 8, v15
    v_add_u32 v1, s70, v15
    v_xor_b32 v2, 64, v1
    v_xor_b32 v3, 128, v1
    v_xor_b32 v4, 192, v1
    s_waitcnt vmcnt(11)
    v_mfma_f32_16x16x32_bf16 v[16:19], v[80:83], v[192:195], 0
    v_mfma_f32_16x16x32_bf16 v[20:23], v[84:87], v[192:195], 0
    v_mfma_f32_16x16x32_bf16 v[24:27], v[88:91], v[192:195], 0
    v_mfma_f32_16x16x32_bf16 v[28:31], v[92:95], v[192:195], 0
    s_waitcnt vmcnt(10)
    v_mfma_f32_16x16x32_bf16 v[32:35], v[80:83], v[196:199], 0
    s_cmp_le_u32 s43, 0
    s_cselect_b32 s71, s33, s32
    s_add_u32 s71, s71, 4096
    buffer_load_dwordx4 v[192:195], v9, s[16:19], s71 offen offset:0 sc1
    v_mfma_f32_16x16x32_bf16 v[36:39], v[84:87], v[196:199], 0
    v_mfma_f32_16x16x32_bf16 v[40:43], v[88:91], v[196:199], 0
    v_mfma_f32_16x16x32_bf16 v[44:47], v[92:95], v[196:199], 0
    s_waitcnt vmcnt(10)
    v_mfma_f32_16x16x32_bf16 v[48:51], v[80:83], v[200:203], 0
    buffer_load_dwordx4 v[196:199], v9, s[16:19], s71 offen offset:1024 sc1
    v_mfma_f32_16x16x32_bf16 v[52:55], v[84:87], v[200:203], 0
    v_mfma_f32_16x16x32_bf16 v[56:59], v[88:91], v[200:203], 0
    v_mfma_f32_16x16x32_bf16 v[60:63], v[92:95], v[200:203], 0
    s_waitcnt vmcnt(10)
    v_mfma_f32_16x16x32_bf16 v[64:67], v[80:83], v[204:207], 0
    buffer_load_dwordx4 v[200:203], v9, s[16:19], s71 offen offset:2048 sc1
    v_mfma_f32_16x16x32_bf16 v[68:71], v[84:87], v[204:207], 0
    v_mfma_f32_16x16x32_bf16 v[72:75], v[88:91], v[204:207], 0
    v_mfma_f32_16x16x32_bf16 v[76:79], v[92:95], v[204:207], 0
    s_waitcnt vmcnt(10)
    v_mfma_f32_16x16x32_bf16 v[16:19], v[96:99], v[208:211], v[16:19]
    buffer_load_dwordx4 v[204:207], v9, s[16:19], s71 offen offset:3072 sc1
    v_mfma_f32_16x16x32_bf16 v[20:23], v[100:103], v[208:211], v[20:23]
    v_mfma_f32_16x16x32_bf16 v[24:27], v[104:107], v[208:211], v[24:27]
    v_mfma_f32_16x16x32_bf16 v[28:31], v[108:111], v[208:211], v[28:31]
    s_waitcnt vmcnt(10)
    v_mfma_f32_16x16x32_bf16 v[32:35], v[96:99], v[212:215], v[32:35]
    s_cmp_le_u32 s43, 1
    s_cselect_b32 s71, s33, s32
    s_add_u32 s71, s71, 16384
    buffer_load_dwordx4 v[208:211], v9, s[16:19], s71 offen offset:0 sc1
    v_mfma_f32_16x16x32_bf16 v[36:39], v[100:103], v[212:215], v[36:39]
    v_mfma_f32_16x16x32_bf16 v[40:43], v[104:107], v[212:215], v[40:43]
    v_mfma_f32_16x16x32_bf16 v[44:47], v[108:111], v[212:215], v[44:47]
    s_waitcnt vmcnt(10)
    v_mfma_f32_16x16x32_bf16 v[48:51], v[96:99], v[216:219], v[48:51]
    buffer_load_dwordx4 v[212:215], v9, s[16:19], s71 offen offset:1024 sc1
    v_mfma_f32_16x16x32_bf16 v[52:55], v[100:103], v[216:219], v[52:55]
    v_mfma_f32_16x16x32_bf16 v[56:59], v[104:107], v[216:219], v[56:59]
    v_mfma_f32_16x16x32_bf16 v[60:63], v[108:111], v[216:219], v[60:63]
    s_waitcnt vmcnt(10)
    v_mfma_f32_16x16x32_bf16 v[64:67], v[96:99], v[220:223], v[64:67]
    buffer_load_dwordx4 v[216:219], v9, s[16:19], s71 offen offset:2048 sc1
    v_mfma_f32_16x16x32_bf16 v[68:71], v[100:103], v[220:223], v[68:71]
    v_mfma_f32_16x16x32_bf16 v[72:75], v[104:107], v[220:223], v[72:75]
    v_mfma_f32_16x16x32_bf16 v[76:79], v[108:111], v[220:223], v[76:79]
    s_waitcnt vmcnt(10)
    v_mfma_f32_16x16x32_bf16 v[16:19], v[112:115], v[224:227], v[16:19]
    buffer_load_dwordx4 v[220:223], v9, s[16:19], s71 offen offset:3072 sc1
    v_mfma_f32_16x16x32_bf16 v[20:23], v[116:119], v[224:227], v[20:23]
    v_mfma_f32_16x16x32_bf16 v[24:27], v[120:123], v[224:227], v[24:27]
    ds_read_b64_tr_b16 v[80:81], v5 offset:49152
    v_mfma_f32_16x16x32_bf16 v[28:31], v[124:127], v[224:227], v[28:31]
    ds_read_b64_tr_b16 v[82:83], v5 offset:51200
    s_waitcnt vmcnt(10)
    v_mfma_f32_16x16x32_bf16 v[32:35], v[112:115], v[228:231], v[32:35]
    s_cmp_le_u32 s43, 1
    s_cselect_b32 s71, s33, s32
    s_add_u32 s71, s71, 20480
    buffer_load_dwordx4 v[224:227], v9, s[16:19], s71 offen offset:0 sc1
    v_mfma_f32_16x16x32_bf16 v[36:39], v[116:119], v[228:231], v[36:39]
    v_mfma_f32_16x16x32_bf16 v[40:43], v[120:123], v[228:231], v[40:43]
    ds_read_b64_tr_b16 v[84:85], v6 offset:49152
    v_mfma_f32_16x16x32_bf16 v[44:47], v[124:127], v[228:231], v[44:47]
    ds_read_b64_tr_b16 v[86:87], v6 offset:51200
    s_waitcnt vmcnt(10)
    v_mfma_f32_16x16x32_bf16 v[48:51], v[112:115], v[232:235], v[48:51]
    buffer_load_dwordx4 v[228:231], v9, s[16:19], s71 offen offset:1024 sc1
    v_mfma_f32_16x16x32_bf16 v[52:55], v[116:119], v[232:235], v[52:55]
    v_mfma_f32_16x16x32_bf16 v[56:59], v[120:123], v[232:235], v[56:59]
    ds_read_b64_tr_b16 v[88:89], v7 offset:49152
    v_mfma_f32_16x16x32_bf16 v[60:63], v[124:127], v[232:235], v[60:63]
    ds_read_b64_tr_b16 v[90:91], v7 offset:51200
    s_waitcnt vmcnt(10)
    v_mfma_f32_16x16x32_bf16 v[64:67], v[112:115], v[236:239], v[64:67]
    buffer_load_dwordx4 v[232:235], v9, s[16:19], s71 offen offset:2048 sc1
    v_mfma_f32_16x16x32_bf16 v[68:71], v[116:119], v[236:239], v[68:71]
    v_mfma_f32_16x16x32_bf16 v[72:75], v[120:123], v[236:239], v[72:75]
    ds_read_b64_tr_b16 v[92:93], v8 offset:49152
    v_mfma_f32_16x16x32_bf16 v[76:79], v[124:127], v[236:239], v[76:79]
    ds_read_b64_tr_b16 v[94:95], v8 offset:51200
    s_waitcnt vmcnt(10)
    v_mfma_f32_16x16x32_bf16 v[16:19], v[128:131], v[192:195], v[16:19]
    buffer_load_dwordx4 v[236:239], v9, s[16:19], s71 offen offset:3072 sc1
    v_mfma_f32_16x16x32_bf16 v[20:23], v[132:135], v[192:195], v[20:23]
    v_mfma_f32_16x16x32_bf16 v[24:27], v[136:139], v[192:195], v[24:27]
    ds_read_b64_tr_b16 v[96:97], v240 offset:16384
    v_mfma_f32_16x16x32_bf16 v[28:31], v[140:143], v[192:195], v[28:31]
    ds_read_b64_tr_b16 v[98:99], v240 offset:18432
    s_waitcnt vmcnt(10)
    v_mfma_f32_16x16x32_bf16 v[32:35], v[128:131], v[196:199], v[32:35]
    s_cmp_le_u32 s43, 2
    s_cselect_b32 s71, s33, s32
    s_add_u32 s71, s71, 32768
    buffer_load_dwordx4 v[192:195], v9, s[16:19], s71 offen offset:0 sc1
    v_mfma_f32_16x16x32_bf16 v[36:39], v[132:135], v[196:199], v[36:39]
    v_mfma_f32_16x16x32_bf16 v[40:43], v[136:139], v[196:199], v[40:43]
    ds_read_b64_tr_b16 v[100:101], v241 offset:16384
    v_mfma_f32_16x16x32_bf16 v[44:47], v[140:143], v[196:199], v[44:47]
    ds_read_b64_tr_b16 v[102:103], v241 offset:18432
    s_waitcnt vmcnt(10)
    v_mfma_f32_16x16x32_bf16 v[48:51], v[128:131], v[200:203], v[48:51]
    buffer_load_dwordx4 v[196:199], v9, s[16:19], s71 offen offset:1024 sc1
    v_mfma_f32_16x16x32_bf16 v[52:55], v[132:135], v[200:203], v[52:55]
    v_mfma_f32_16x16x32_bf16 v[56:59], v[136:139], v[200:203], v[56:59]
    ds_read_b64_tr_b16 v[104:105], v242 offset:16384
    v_mfma_f32_16x16x32_bf16 v[60:63], v[140:143], v[200:203], v[60:63]
    ds_read_b64_tr_b16 v[106:107], v242 offset:18432
    s_waitcnt vmcnt(10)
    v_mfma_f32_16x16x32_bf16 v[64:67], v[128:131], v[204:207], v[64:67]
    buffer_load_dwordx4 v[200:203], v9, s[16:19], s71 offen offset:2048 sc1
    v_mfma_f32_16x16x32_bf16 v[68:71], v[132:135], v[204:207], v[68:71]
    v_mfma_f32_16x16x32_bf16 v[72:75], v[136:139], v[204:207], v[72:75]
    ds_read_b64_tr_b16 v[108:109], v243 offset:16384
    v_mfma_f32_16x16x32_bf16 v[76:79], v[140:143], v[204:207], v[76:79]
    ds_read_b64_tr_b16 v[110:111], v243 offset:18432
    s_waitcnt vmcnt(10)
    v_mfma_f32_16x16x32_bf16 v[16:19], v[144:147], v[208:211], v[16:19]
    buffer_load_dwordx4 v[204:207], v9, s[16:19], s71 offen offset:3072 sc1
    v_mfma_f32_16x16x32_bf16 v[20:23], v[148:151], v[208:211], v[20:23]
    v_mfma_f32_16x16x32_bf16 v[24:27], v[152:155], v[208:211], v[24:27]
    ds_read_b64_tr_b16 v[112:113], v240 offset:0
    v_mfma_f32_16x16x32_bf16 v[28:31], v[156:159], v[208:211], v[28:31]
    ds_read_b64_tr_b16 v[114:115], v240 offset:2048
    s_waitcnt vmcnt(10)
    v_mfma_f32_16x16x32_bf16 v[32:35], v[144:147], v[212:215], v[32:35]
    s_cmp_le_u32 s43, 2
    s_cselect_b32 s71, s33, s32
    s_add_u32 s71, s71, 36864
    buffer_load_dwordx4 v[208:211], v9, s[16:19], s71 offen offset:0 sc1
    v_mfma_f32_16x16x32_bf16 v[36:39], v[148:151], v[212:215], v[36:39]
    v_mfma_f32_16x16x32_bf16 v[40:43], v[152:155], v[212:215], v[40:43]
    ds_read_b64_tr_b16 v[116:117], v241 offset:0
    v_mfma_f32_16x16x32_bf16 v[44:47], v[156:159], v[212:215], v[44:47]
    ds_read_b64_tr_b16 v[118:119], v241 offset:2048
    s_waitcnt vmcnt(10)
    v_mfma_f32_16x16x32_bf16 v[48:51], v[144:147], v[216:219], v[48:51]
    buffer_load_dwordx4 v[212:215], v9, s[16:19], s71 offen offset:1024 sc1
    v_mfma_f32_16x16x32_bf16 v[52:55], v[148:151], v[216:219], v[52:55]
    v_mfma_f32_16x16x32_bf16 v[56:59], v[152:155], v[216:219], v[56:59]
    ds_read_b64_tr_b16 v[120:121], v242 offset:0
    v_mfma_f32_16x16x32_bf16 v[60:63], v[156:159], v[216:219], v[60:63]
    ds_read_b64_tr_b16 v[122:123], v242 offset:2048
    s_waitcnt vmcnt(10)
    v_mfma_f32_16x16x32_bf16 v[64:67], v[144:147], v[220:223], v[64:67]
    buffer_load_dwordx4 v[216:219], v9, s[16:19], s71 offen offset:2048 sc1
    v_mfma_f32_16x16x32_bf16 v[68:71], v[148:151], v[220:223], v[68:71]
    v_mfma_f32_16x16x32_bf16 v[72:75], v[152:155], v[220:223], v[72:75]
    ds_read_b64_tr_b16 v[124:125], v243 offset:0
    v_mfma_f32_16x16x32_bf16 v[76:79], v[156:159], v[220:223], v[76:79]
    ds_read_b64_tr_b16 v[126:127], v243 offset:2048
    s_waitcnt vmcnt(10)
    v_mfma_f32_16x16x32_bf16 v[16:19], v[160:163], v[224:227], v[16:19]
    buffer_load_dwordx4 v[220:223], v9, s[16:19], s71 offen offset:3072 sc1
    v_mfma_f32_16x16x32_bf16 v[20:23], v[164:167], v[224:227], v[20:23]
    v_mfma_f32_16x16x32_bf16 v[24:27], v[168:171], v[224:227], v[24:27]
    ds_read_b64_tr_b16 v[128:129], v240 offset:32768
    v_mfma_f32_16x16x32_bf16 v[28:31], v[172:175], v[224:227], v[28:31]
    ds_read_b64_tr_b16 v[130:131], v240 offset:34816
    s_waitcnt vmcnt(10)
    v_mfma_f32_16x16x32_bf16 v[32:35], v[160:163], v[228:231], v[32:35]
    s_cmp_le_u32 s43, 3
    s_cselect_b32 s71, s33, s32
    s_add_u32 s71, s71, 49152
    buffer_load_dwordx4 v[224:227], v9, s[16:19], s71 offen offset:0 sc1
    v_mfma_f32_16x16x32_bf16 v[36:39], v[164:167], v[228:231], v[36:39]
    v_mfma_f32_16x16x32_bf16 v[40:43], v[168:171], v[228:231], v[40:43]
    ds_read_b64_tr_b16 v[132:133], v241 offset:32768
    v_mfma_f32_16x16x32_bf16 v[44:47], v[172:175], v[228:231], v[44:47]
    ds_read_b64_tr_b16 v[134:135], v241 offset:34816
    s_waitcnt vmcnt(10)
    v_mfma_f32_16x16x32_bf16 v[48:51], v[160:163], v[232:235], v[48:51]
    buffer_load_dwordx4 v[228:231], v9, s[16:19], s71 offen offset:1024 sc1
    v_mfma_f32_16x16x32_bf16 v[52:55], v[164:167], v[232:235], v[52:55]
    v_mfma_f32_16x16x32_bf16 v[56:59], v[168:171], v[232:235], v[56:59]
    ds_read_b64_tr_b16 v[136:137], v242 offset:32768
    v_mfma_f32_16x16x32_bf16 v[60:63], v[172:175], v[232:235], v[60:63]
    ds_read_b64_tr_b16 v[138:139], v242 offset:34816
    s_waitcnt vmcnt(10)
    v_mfma_f32_16x16x32_bf16 v[64:67], v[160:163], v[236:239], v[64:67]
    buffer_load_dwordx4 v[232:235], v9, s[16:19], s71 offen offset:2048 sc1
    v_mfma_f32_16x16x32_bf16 v[68:71], v[164:167], v[236:239], v[68:71]
    v_mfma_f32_16x16x32_bf16 v[72:75], v[168:171], v[236:239], v[72:75]
    ds_read_b64_tr_b16 v[140:141], v243 offset:32768
    v_mfma_f32_16x16x32_bf16 v[76:79], v[172:175], v[236:239], v[76:79]
    ds_read_b64_tr_b16 v[142:143], v243 offset:34816
    s_waitcnt vmcnt(10)
    v_mfma_f32_16x16x32_bf16 v[16:19], v[176:179], v[192:195], v[16:19]
    buffer_load_dwordx4 v[236:239], v9, s[16:19], s71 offen offset:3072 sc1
    v_mfma_f32_16x16x32_bf16 v[20:23], v[180:183], v[192:195], v[20:23]
    v_mfma_f32_16x16x32_bf16 v[24:27], v[184:187], v[192:195], v[24:27]
    ds_read_b64_tr_b16 v[144:145], v5 offset:16384
    v_mfma_f32_16x16x32_bf16 v[28:31], v[188:191], v[192:195], v[28:31]
    ds_read_b64_tr_b16 v[146:147], v5 offset:18432
    s_waitcnt vmcnt(10)
    v_mfma_f32_16x16x32_bf16 v[32:35], v[176:179], v[196:199], v[32:35]
    s_cmp_le_u32 s43, 3
    s_cselect_b32 s52, s33, s32
    s_add_u32 s52, s52, 53248
    buffer_load_dwordx4 v[192:195], v9, s[16:19], s52 offen offset:0 sc1
    v_mfma_f32_16x16x32_bf16 v[36:39], v[180:183], v[196:199], v[36:39]
    v_mfma_f32_16x16x32_bf16 v[40:43], v[184:187], v[196:199], v[40:43]
    ds_read_b64_tr_b16 v[148:149], v6 offset:16384
    v_mfma_f32_16x16x32_bf16 v[44:47], v[188:191], v[196:199], v[44:47]
    ds_read_b64_tr_b16 v[150:151], v6 offset:18432
    s_waitcnt vmcnt(10)
    v_mfma_f32_16x16x32_bf16 v[48:51], v[176:179], v[200:203], v[48:51]
    s_cmp_le_u32 s43, 4
    s_cselect_b32 s53, s33, s32
    s_add_u32 s53, s53, 65536
    buffer_load_dwordx4 v[196:199], v9, s[16:19], s53 offen offset:0 sc1
    v_mfma_f32_16x16x32_bf16 v[52:55], v[180:183], v[200:203], v[52:55]
    v_mfma_f32_16x16x32_bf16 v[56:59], v[184:187], v[200:203], v[56:59]
    ds_read_b64_tr_b16 v[152:153], v7 offset:16384
    v_mfma_f32_16x16x32_bf16 v[60:63], v[188:191], v[200:203], v[60:63]
    ds_read_b64_tr_b16 v[154:155], v7 offset:18432
    s_waitcnt vmcnt(10)
    v_mfma_f32_16x16x32_bf16 v[64:67], v[176:179], v[204:207], v[64:67]
    s_cmp_le_u32 s43, 4
    s_cselect_b32 s54, s33, s32
    s_add_u32 s54, s54, 69632
    buffer_load_dwordx4 v[200:203], v9, s[16:19], s54 offen offset:0 sc1
    v_mfma_f32_16x16x32_bf16 v[68:71], v[180:183], v[204:207], v[68:71]
    v_mfma_f32_16x16x32_bf16 v[72:75], v[184:187], v[204:207], v[72:75]
    ds_read_b64_tr_b16 v[156:157], v8 offset:16384
    v_mfma_f32_16x16x32_bf16 v[76:79], v[188:191], v[204:207], v[76:79]
    ds_read_b64_tr_b16 v[158:159], v8 offset:18432
    s_waitcnt vmcnt(10) lgkmcnt(15)
    v_mfma_f32_16x16x32_bf16 v[16:19], v[80:83], v[208:211], v[16:19]
    s_cmp_le_u32 s43, 5
    s_cselect_b32 s55, s33, s32
    s_add_u32 s55, s55, 81920
    buffer_load_dwordx4 v[204:207], v9, s[16:19], s55 offen offset:0 sc1
    v_mfma_f32_16x16x32_bf16 v[20:23], v[84:87], v[208:211], v[20:23]
    v_mfma_f32_16x16x32_bf16 v[24:27], v[88:91], v[208:211], v[24:27]
    ds_read_b64_tr_b16 v[160:161], v5 offset:0
    v_mfma_f32_16x16x32_bf16 v[28:31], v[92:95], v[208:211], v[28:31]
    ds_read_b64_tr_b16 v[162:163], v5 offset:2048
    s_waitcnt vmcnt(10)
    v_mfma_f32_16x16x32_bf16 v[32:35], v[80:83], v[212:215], v[32:35]
    s_cmp_le_u32 s43, 5
    s_cselect_b32 s56, s33, s32
    s_add_u32 s56, s56, 86016
    buffer_load_dwordx4 v[208:211], v9, s[16:19], s56 offen offset:0 sc1
    v_mfma_f32_16x16x32_bf16 v[36:39], v[84:87], v[212:215], v[36:39]
    v_mfma_f32_16x16x32_bf16 v[40:43], v[88:91], v[212:215], v[40:43]
    ds_read_b64_tr_b16 v[164:165], v6 offset:0
    v_mfma_f32_16x16x32_bf16 v[44:47], v[92:95], v[212:215], v[44:47]
    ds_read_b64_tr_b16 v[166:167], v6 offset:2048
    s_waitcnt vmcnt(10)
    v_mfma_f32_16x16x32_bf16 v[48:51], v[80:83], v[216:219], v[48:51]
    buffer_load_dwordx4 v[212:215], v9, s[16:19], s52 offen offset:1024 sc1
    v_mfma_f32_16x16x32_bf16 v[52:55], v[84:87], v[216:219], v[52:55]
    v_mfma_f32_16x16x32_bf16 v[56:59], v[88:91], v[216:219], v[56:59]
    ds_read_b64_tr_b16 v[168:169], v7 offset:0
    v_mfma_f32_16x16x32_bf16 v[60:63], v[92:95], v[216:219], v[60:63]
    ds_read_b64_tr_b16 v[170:171], v7 offset:2048
    s_waitcnt vmcnt(10)
    v_mfma_f32_16x16x32_bf16 v[64:67], v[80:83], v[220:223], v[64:67]
    buffer_load_dwordx4 v[216:219], v9, s[16:19], s53 offen offset:1024 sc1
    v_mfma_f32_16x16x32_bf16 v[68:71], v[84:87], v[220:223], v[68:71]
    v_mfma_f32_16x16x32_bf16 v[72:75], v[88:91], v[220:223], v[72:75]
    ds_read_b64_tr_b16 v[172:173], v8 offset:0
    v_mfma_f32_16x16x32_bf16 v[76:79], v[92:95], v[220:223], v[76:79]
    ds_read_b64_tr_b16 v[174:175], v8 offset:2048
    s_waitcnt vmcnt(10)
    v_mfma_f32_16x16x32_bf16 v[16:19], v[96:99], v[224:227], v[16:19]
    buffer_load_dwordx4 v[220:223], v9, s[16:19], s54 offen offset:1024 sc1
    v_mfma_f32_16x16x32_bf16 v[20:23], v[100:103], v[224:227], v[20:23]
    v_mfma_f32_16x16x32_bf16 v[24:27], v[104:107], v[224:227], v[24:27]
    ds_read_b64_tr_b16 v[176:177], v5 offset:32768
    v_mfma_f32_16x16x32_bf16 v[28:31], v[108:111], v[224:227], v[28:31]
    ds_read_b64_tr_b16 v[178:179], v5 offset:34816
    s_waitcnt vmcnt(10)
    v_mfma_f32_16x16x32_bf16 v[32:35], v[96:99], v[228:231], v[32:35]
    buffer_load_dwordx4 v[224:227], v9, s[16:19], s55 offen offset:1024 sc1
    v_mfma_f32_16x16x32_bf16 v[36:39], v[100:103], v[228:231], v[36:39]
    v_mfma_f32_16x16x32_bf16 v[40:43], v[104:107], v[228:231], v[40:43]
    ds_read_b64_tr_b16 v[180:181], v6 offset:32768
    v_mfma_f32_16x16x32_bf16 v[44:47], v[108:111], v[228:231], v[44:47]
    ds_read_b64_tr_b16 v[182:183], v6 offset:34816
    s_waitcnt vmcnt(10)
    v_mfma_f32_16x16x32_bf16 v[48:51], v[96:99], v[232:235], v[48:51]
    buffer_load_dwordx4 v[228:231], v9, s[16:19], s56 offen offset:1024 sc1
    v_mfma_f32_16x16x32_bf16 v[52:55], v[100:103], v[232:235], v[52:55]
    v_mfma_f32_16x16x32_bf16 v[56:59], v[104:107], v[232:235], v[56:59]
    ds_read_b64_tr_b16 v[184:185], v7 offset:32768
    v_mfma_f32_16x16x32_bf16 v[60:63], v[108:111], v[232:235], v[60:63]
    ds_read_b64_tr_b16 v[186:187], v7 offset:34816
    s_waitcnt vmcnt(10)
    v_mfma_f32_16x16x32_bf16 v[64:67], v[96:99], v[236:239], v[64:67]
    buffer_load_dwordx4 v[232:235], v9, s[16:19], s52 offen offset:2048 sc1
    v_mfma_f32_16x16x32_bf16 v[68:71], v[100:103], v[236:239], v[68:71]
    v_mfma_f32_16x16x32_bf16 v[72:75], v[104:107], v[236:239], v[72:75]
    ds_read_b64_tr_b16 v[188:189], v8 offset:32768
    v_mfma_f32_16x16x32_bf16 v[76:79], v[108:111], v[236:239], v[76:79]
    ds_read_b64_tr_b16 v[190:191], v8 offset:34816
    s_waitcnt vmcnt(10)
    v_mfma_f32_16x16x32_bf16 v[16:19], v[112:115], v[192:195], v[16:19]
    buffer_load_dwordx4 v[236:239], v9, s[16:19], s53 offen offset:2048 sc1
    v_mfma_f32_16x16x32_bf16 v[20:23], v[116:119], v[192:195], v[20:23]
    v_mfma_f32_16x16x32_bf16 v[24:27], v[120:123], v[192:195], v[24:27]
    v_mfma_f32_16x16x32_bf16 v[28:31], v[124:127], v[192:195], v[28:31]
    s_waitcnt vmcnt(10) lgkmcnt(15)
    v_mfma_f32_16x16x32_bf16 v[16:19], v[128:131], v[196:199], v[16:19]
    buffer_load_dwordx4 v[192:195], v9, s[16:19], s54 offen offset:2048 sc1
    v_mfma_f32_16x16x32_bf16 v[20:23], v[132:135], v[196:199], v[20:23]
    v_mfma_f32_16x16x32_bf16 v[24:27], v[136:139], v[196:199], v[24:27]
    v_mfma_f32_16x16x32_bf16 v[28:31], v[140:143], v[196:199], v[28:31]
    s_waitcnt vmcnt(10)
    v_mfma_f32_16x16x32_bf16 v[16:19], v[144:147], v[200:203], v[16:19]
    buffer_load_dwordx4 v[196:199], v9, s[16:19], s55 offen offset:2048 sc1
    v_mfma_f32_16x16x32_bf16 v[20:23], v[148:151], v[200:203], v[20:23]
    v_mfma_f32_16x16x32_bf16 v[24:27], v[152:155], v[200:203], v[24:27]
    v_mfma_f32_16x16x32_bf16 v[28:31], v[156:159], v[200:203], v[28:31]
    s_waitcnt vmcnt(10) lgkmcnt(8)
    v_mfma_f32_16x16x32_bf16 v[16:19], v[160:163], v[204:207], v[16:19]
    buffer_load_dwordx4 v[200:203], v9, s[16:19], s56 offen offset:2048 sc1
    v_mfma_f32_16x16x32_bf16 v[20:23], v[164:167], v[204:207], v[20:23]
    v_mfma_f32_16x16x32_bf16 v[24:27], v[168:171], v[204:207], v[24:27]
    v_mfma_f32_16x16x32_bf16 v[28:31], v[172:175], v[204:207], v[28:31]
    s_waitcnt vmcnt(10) lgkmcnt(0)
    v_mfma_f32_16x16x32_bf16 v[16:19], v[176:179], v[208:211], v[16:19]
    buffer_load_dwordx4 v[204:207], v9, s[16:19], s52 offen offset:3072 sc1
    v_mfma_f32_16x16x32_bf16 v[20:23], v[180:183], v[208:211], v[20:23]
    v_mfma_f32_16x16x32_bf16 v[24:27], v[184:187], v[208:211], v[24:27]
    v_mfma_f32_16x16x32_bf16 v[28:31], v[188:191], v[208:211], v[28:31]
    s_waitcnt vmcnt(10)
    v_mfma_f32_16x16x32_bf16 v[32:35], v[112:115], v[212:215], v[32:35]
    buffer_load_dwordx4 v[208:211], v9, s[16:19], s53 offen offset:3072 sc1
    v_mfma_f32_16x16x32_bf16 v[36:39], v[116:119], v[212:215], v[36:39]
    v_mfma_f32_16x16x32_bf16 v[40:43], v[120:123], v[212:215], v[40:43]
    v_mfma_f32_16x16x32_bf16 v[44:47], v[124:127], v[212:215], v[44:47]
    ds_write_b128 v1, v[16:19] offset:0
    s_waitcnt vmcnt(10)
    v_mfma_f32_16x16x32_bf16 v[32:35], v[128:131], v[216:219], v[32:35]
    buffer_load_dwordx4 v[212:215], v9, s[16:19], s54 offen offset:3072 sc1
    v_mfma_f32_16x16x32_bf16 v[36:39], v[132:135], v[216:219], v[36:39]
    v_mfma_f32_16x16x32_bf16 v[40:43], v[136:139], v[216:219], v[40:43]
    v_mfma_f32_16x16x32_bf16 v[44:47], v[140:143], v[216:219], v[44:47]
    ds_write_b128 v2, v[20:23] offset:0
    s_waitcnt vmcnt(10)
    v_mfma_f32_16x16x32_bf16 v[32:35], v[144:147], v[220:223], v[32:35]
    buffer_load_dwordx4 v[216:219], v9, s[16:19], s55 offen offset:3072 sc1
    v_mfma_f32_16x16x32_bf16 v[36:39], v[148:151], v[220:223], v[36:39]
    v_mfma_f32_16x16x32_bf16 v[40:43], v[152:155], v[220:223], v[40:43]
    v_mfma_f32_16x16x32_bf16 v[44:47], v[156:159], v[220:223], v[44:47]
    ds_write_b128 v3, v[24:27] offset:0
    s_waitcnt vmcnt(10)
    v_mfma_f32_16x16x32_bf16 v[32:35], v[160:163], v[224:227], v[32:35]
    buffer_load_dwordx4 v[220:223], v9, s[16:19], s56 offen offset:3072 sc1
    v_mfma_f32_16x16x32_bf16 v[36:39], v[164:167], v[224:227], v[36:39]
    v_mfma_f32_16x16x32_bf16 v[40:43], v[168:171], v[224:227], v[40:43]
    v_mfma_f32_16x16x32_bf16 v[44:47], v[172:175], v[224:227], v[44:47]
    ds_write_b128 v4, v[28:31] offset:0
    s_waitcnt vmcnt(10)
    v_mfma_f32_16x16x32_bf16 v[32:35], v[176:179], v[228:231], v[32:35]
    v_mfma_f32_16x16x32_bf16 v[36:39], v[180:183], v[228:231], v[36:39]
    v_mfma_f32_16x16x32_bf16 v[40:43], v[184:187], v[228:231], v[40:43]
    v_mfma_f32_16x16x32_bf16 v[44:47], v[188:191], v[228:231], v[44:47]
    s_waitcnt vmcnt(9)
    v_mfma_f32_16x16x32_bf16 v[48:51], v[112:115], v[232:235], v[48:51]
    v_mfma_f32_16x16x32_bf16 v[52:55], v[116:119], v[232:235], v[52:55]
    v_mfma_f32_16x16x32_bf16 v[56:59], v[120:123], v[232:235], v[56:59]
    v_mfma_f32_16x16x32_bf16 v[60:63], v[124:127], v[232:235], v[60:63]
    ds_write_b128 v1, v[32:35] offset:16384
    s_waitcnt vmcnt(8)
    v_mfma_f32_16x16x32_bf16 v[48:51], v[128:131], v[236:239], v[48:51]
    v_mfma_f32_16x16x32_bf16 v[52:55], v[132:135], v[236:239], v[52:55]
    v_mfma_f32_16x16x32_bf16 v[56:59], v[136:139], v[236:239], v[56:59]
    v_mfma_f32_16x16x32_bf16 v[60:63], v[140:143], v[236:239], v[60:63]
    ds_write_b128 v2, v[36:39] offset:16384
    s_waitcnt vmcnt(7)
    v_mfma_f32_16x16x32_bf16 v[48:51], v[144:147], v[192:195], v[48:51]
    v_mfma_f32_16x16x32_bf16 v[52:55], v[148:151], v[192:195], v[52:55]
    v_mfma_f32_16x16x32_bf16 v[56:59], v[152:155], v[192:195], v[56:59]
    v_mfma_f32_16x16x32_bf16 v[60:63], v[156:159], v[192:195], v[60:63]
    ds_write_b128 v3, v[40:43] offset:16384
    s_waitcnt vmcnt(6)
    v_mfma_f32_16x16x32_bf16 v[48:51], v[160:163], v[196:199], v[48:51]
    v_mfma_f32_16x16x32_bf16 v[52:55], v[164:167], v[196:199], v[52:55]
    v_mfma_f32_16x16x32_bf16 v[56:59], v[168:171], v[196:199], v[56:59]
    v_mfma_f32_16x16x32_bf16 v[60:63], v[172:175], v[196:199], v[60:63]
    ds_write_b128 v4, v[44:47] offset:16384
    s_mov_b64 exec, 1
    ds_add_u32 v12, v13 offset:0
    s_mov_b64 exec, -1
    s_waitcnt vmcnt(5)
    v_mfma_f32_16x16x32_bf16 v[48:51], v[176:179], v[200:203], v[48:51]
    v_mfma_f32_16x16x32_bf16 v[52:55], v[180:183], v[200:203], v[52:55]
    v_mfma_f32_16x16x32_bf16 v[56:59], v[184:187], v[200:203], v[56:59]
    v_mfma_f32_16x16x32_bf16 v[60:63], v[188:191], v[200:203], v[60:63]
    s_waitcnt vmcnt(4)
    v_mfma_f32_16x16x32_bf16 v[64:67], v[112:115], v[204:207], v[64:67]
    v_mfma_f32_16x16x32_bf16 v[68:71], v[116:119], v[204:207], v[68:71]
    v_mfma_f32_16x16x32_bf16 v[72:75], v[120:123], v[204:207], v[72:75]
    v_mfma_f32_16x16x32_bf16 v[76:79], v[124:127], v[204:207], v[76:79]
    ds_write_b128 v1, v[48:51] offset:32768
    s_waitcnt vmcnt(3)
    v_mfma_f32_16x16x32_bf16 v[64:67], v[128:131], v[208:211], v[64:67]
    v_mfma_f32_16x16x32_bf16 v[68:71], v[132:135], v[208:211], v[68:71]
    v_mfma_f32_16x16x32_bf16 v[72:75], v[136:139], v[208:211], v[72:75]
    v_mfma_f32_16x16x32_bf16 v[76:79], v[140:143], v[208:211], v[76:79]
    ds_write_b128 v2, v[52:55] offset:32768
    s_waitcnt vmcnt(2)
    v_mfma_f32_16x16x32_bf16 v[64:67], v[144:147], v[212:215], v[64:67]
    v_mfma_f32_16x16x32_bf16 v[68:71], v[148:151], v[212:215], v[68:71]
    v_mfma_f32_16x16x32_bf16 v[72:75], v[152:155], v[212:215], v[72:75]
    v_mfma_f32_16x16x32_bf16 v[76:79], v[156:159], v[212:215], v[76:79]
    ds_write_b128 v3, v[56:59] offset:32768
    s_waitcnt vmcnt(1)
    v_mfma_f32_16x16x32_bf16 v[64:67], v[160:163], v[216:219], v[64:67]
    v_mfma_f32_16x16x32_bf16 v[68:71], v[164:167], v[216:219], v[68:71]
    v_mfma_f32_16x16x32_bf16 v[72:75], v[168:171], v[216:219], v[72:75]
    v_mfma_f32_16x16x32_bf16 v[76:79], v[172:175], v[216:219], v[76:79]
    ds_write_b128 v4, v[60:63] offset:32768
    s_waitcnt vmcnt(0)
    v_mfma_f32_16x16x32_bf16 v[64:67], v[176:179], v[220:223], v[64:67]
    v_mfma_f32_16x16x32_bf16 v[68:71], v[180:183], v[220:223], v[68:71]
    v_mfma_f32_16x16x32_bf16 v[72:75], v[184:187], v[220:223], v[72:75]
    v_mfma_f32_16x16x32_bf16 v[76:79], v[188:191], v[220:223], v[76:79]
    s_nop 4
    ds_write_b128 v1, v[64:67] offset:49152
    ds_write_b128 v2, v[68:71] offset:49152
    ds_write_b128 v3, v[72:75] offset:49152
    ds_write_b128 v4, v[76:79] offset:49152
    s_waitcnt lgkmcnt(0)
    s_barrier
    s_endpgm
    .p2align 12
L_S:
    s_waitcnt lgkmcnt(7)
    v_mfma_f32_32x32x16_bf16 v[224:239], v[192:195], v[160:163], 0
    s_add_u32 m0, s70, 98304
    s_nop 0
    buffer_load_dwordx4 v132, s[8:11], s77 offen offset:0 lds
    s_waitcnt lgkmcnt(6)
    v_mfma_f32_32x32x16_bf16 v[224:239], v[196:199], v[164:167], v[224:239]
    s_mov_b64 s[20:21], s[56:57]
    s_mov_b32 s22, 256
    s_mov_b32 s23, 0x20000
    s_waitcnt lgkmcnt(5)
    v_mfma_f32_32x32x16_bf16 v[224:239], v[200:203], v[168:171], v[224:239]
    buffer_load_dwordx4 v133, s[8:11], s77 offen offset:1024 lds
    s_waitcnt lgkmcnt(4)
    v_mfma_f32_32x32x16_bf16 v[224:239], v[204:207], v[172:175], v[224:239]
    v_mov_b32 v34, 13312
    v_mov_b32 v35, 1
    s_movk_i32 s50, 128
    s_mov_b32 s51, 229376
    s_waitcnt lgkmcnt(3)
    v_mfma_f32_32x32x16_bf16 v[224:239], v[208:211], v[176:179], v[224:239]
    buffer_load_dwordx4 v134, s[8:11], s77 offen offset:2048 lds
    s_waitcnt lgkmcnt(2)
    v_mfma_f32_32x32x16_bf16 v[224:239], v[212:215], v[180:183], v[224:239]
    s_waitcnt lgkmcnt(1)
    v_mfma_f32_32x32x16_bf16 v[224:239], v[216:219], v[184:187], v[224:239]
    buffer_load_dwordx4 v135, s[8:11], s77 offen offset:3072 lds
    s_add_u32 s76, s76, 128
    s_add_u32 s77, s77, 229376
    s_cmp_ge_u32 s77, 1605632
    s_cselect_b32 s34, 896, 0
    s_cselect_b32 s35, 1605632, 0
    s_sub_u32 s76, s76, s34
    s_sub_u32 s77, s77, s35
    s_waitcnt lgkmcnt(0)
    v_mfma_f32_32x32x16_bf16 v[224:239], v[220:223], v[188:191], v[224:239]
    global_load_dwordx4 v[68:71], v[76:77], off
    global_load_dwordx4 v[72:75], v[76:77], off offset:1024
    s_branch L_pad_g1
L_ret_g1:
    s_barrier
    s_setprio 0
    buffer_load_dword v49, off, s[20:23], 0 sc1
    s_add_u32 m0, s70, 16384
    s_nop 0
    buffer_load_dwordx4 v150, s[4:7], s76 offen offset:0 lds
    v_lshrrev_b32 v50, 1, v0
    v_and_b32 v52, 1, v0
    v_lshl_add_u32 v52, s69, 1, v52
    v_bfe_u32 v51, v0, 2, 3
    v_xor_b32 v51, v51, v52
    buffer_load_dwordx4 v151, s[4:7], s76 offen offset:1024 lds
    v_lshlrev_b32 v51, 4, v51
    v_lshl_add_u32 v51, v50, 7, v51
    s_and_b32 s71, s60, 1
    s_lshl_b32 s71, s71, 13
    s_add_u32 s71, s71, 98304
    buffer_load_dwordx4 v152, s[4:7], s76 offen offset:2048 lds
    v_add_u32 v51, s71, v51
    ds_read_b128 v[248:251], v51
    ds_read_b128 v[252:255], v51 offset:4096
    buffer_load_dwordx4 v153, s[4:7], s76 offen offset:3072 lds
    s_mul_i32 s71, s68, 16640
    s_add_u32 s71, s71, 14336
    s_lshl_b32 s72, s40, 10
    s_add_u32 s72, s72, s71
    v_lshl_add_u32 v64, v0, 4, s72
    s_add_u32 m0, s70, 0
    s_nop 0
    buffer_load_dwordx4 v132, s[8:11], s77 offen offset:0 lds
    s_cmp_ge_u32 s77, 1376256
    s_cselect_b32 s34, -768, s50
    s_cselect_b32 s35, -1376256, s51
    s_add_u32 s76, s76, s34
    v_bfe_u32 v2, v0, 1, 2
    v_mul_u32_u24 v2, 4160, v2
    v_and_b32 v29, 1, v0
    v_lshl_add_u32 v2, v29, 4, v2
    v_add_u32 v48, s71, v2
    buffer_load_dwordx4 v133, s[8:11], s77 offen offset:1024 lds
    s_lshr_b32 s71, s67, 4
    s_lshl_b32 s71, s71, 2
    s_add_u32 s71, s71, 128
    s_lshl_b32 s71, s71, 7
    v_and_b32 v2, 3, v0
    buffer_load_dwordx4 v134, s[8:11], s77 offen offset:2048 lds
    v_lshl_add_u32 v26, v2, 7, s71
    s_lshl_b32 s71, s67, 13
    s_add_u32 s71, s71, 1048576
    v_lshl_add_u32 v2, s69, 6, v0
    v_and_b32 v3, 0xfc, v2
    buffer_load_dwordx4 v135, s[8:11], s77 offen offset:3072 lds
    s_add_u32 s77, s77, s35
    v_add_u32 v3, v3, v2
    v_lshl_add_u32 v28, v3, 4, s71
    v_lshlrev_b32 v27, 4, v2
    v_add_u32 v67, 480, v27
    s_mov_b32 s30, 32768
    s_mov_b32 s31, 36864
    s_waitcnt vmcnt(11) lgkmcnt(0)
    s_barrier
    s_add_u32 m0, s70, 49152
    s_nop 0
    buffer_load_dwordx4 v150, s[4:7], s76 offen offset:0 lds
    buffer_load_dwordx4 v151, s[4:7], s76 offen offset:1024 lds
    s_mov_b32 s73, 0
    s_waitcnt vmcnt(10)
L_vp_16:
    v_cmp_gt_u32 vcc, 4, v49
    s_add_u32 s73, s73, 1
    s_cmp_gt_u32 s73, 1000000
    s_cbranch_scc1 L_vpo_17
    s_cbranch_vccz L_vpo_17
    s_sleep 2
    buffer_load_dword v49, off, s[20:23], 0 sc1
    s_waitcnt vmcnt(0)
    s_branch L_vp_16
L_vpo_17:
    s_lshl_b32 s71, s41, 2
    s_add_u32 s71, s71, s62
    s_add_u32 s71, s71, 128
    s_lshl_b32 s71, s71, 7
    s_cmp_lg_u32 s69, 0
    s_cbranch_scc1 L_xf_18
    s_mov_b32 s38, 1
    s_atomic_add s38, s[58:59], s71
L_xf_18:
    buffer_load_dwordx4 v152, s[4:7], s76 offen offset:2048 lds
    buffer_load_dwordx4 v153, s[4:7], s76 offen offset:3072 lds
    s_mul_i32 s71, s68, 6864
    s_add_u32 s71, s71, 84464
    v_add_u32_sdwa v8, s71, v68 dst_sel:DWORD dst_unused:UNUSED_PAD src0_sel:DWORD src1_sel:WORD_0
    v_add_u32_sdwa v9, s71, v68 dst_sel:DWORD dst_unused:UNUSED_PAD src0_sel:DWORD src1_sel:WORD_1
    v_add_u32_sdwa v10, s71, v69 dst_sel:DWORD dst_unused:UNUSED_PAD src0_sel:DWORD src1_sel:WORD_0
    s_add_u32 m0, s70, 81920
    s_nop 0
    buffer_load_dwordx4 v132, s[8:11], s77 offen offset:0 lds
    s_cmp_ge_u32 s77, 1376256
    s_cselect_b32 s34, -768, s50
    s_cselect_b32 s35, -1376256, s51
    s_add_u32 s76, s76, s34
    v_add_u32_sdwa v11, s71, v69 dst_sel:DWORD dst_unused:UNUSED_PAD src0_sel:DWORD src1_sel:WORD_1
    v_add_u32_sdwa v12, s71, v70 dst_sel:DWORD dst_unused:UNUSED_PAD src0_sel:DWORD src1_sel:WORD_0
    v_add_u32_sdwa v13, s71, v70 dst_sel:DWORD dst_unused:UNUSED_PAD src0_sel:DWORD src1_sel:WORD_1
    v_add_u32_sdwa v14, s71, v71 dst_sel:DWORD dst_unused:UNUSED_PAD src0_sel:DWORD src1_sel:WORD_0
    v_add_u32_sdwa v15, s71, v71 dst_sel:DWORD dst_unused:UNUSED_PAD src0_sel:DWORD src1_sel:WORD_1
    buffer_load_dwordx4 v133, s[8:11], s77 offen offset:1024 lds
    v_add_u32_sdwa v16, s71, v72 dst_sel:DWORD dst_unused:UNUSED_PAD src0_sel:DWORD src1_sel:WORD_0
    v_add_u32_sdwa v17, s71, v72 dst_sel:DWORD dst_unused:UNUSED_PAD src0_sel:DWORD src1_sel:WORD_1
    v_add_u32_sdwa v18, s71, v73 dst_sel:DWORD dst_unused:UNUSED_PAD src0_sel:DWORD src1_sel:WORD_0
    v_add_u32_sdwa v19, s71, v73 dst_sel:DWORD dst_unused:UNUSED_PAD src0_sel:DWORD src1_sel:WORD_1
    v_add_u32_sdwa v20, s71, v74 dst_sel:DWORD dst_unused:UNUSED_PAD src0_sel:DWORD src1_sel:WORD_0
    buffer_load_dwordx4 v134, s[8:11], s77 offen offset:2048 lds
    v_add_u32_sdwa v21, s71, v74 dst_sel:DWORD dst_unused:UNUSED_PAD src0_sel:DWORD src1_sel:WORD_1
    s_mul_i32 s71, s68, 16640
    s_add_u32 s71, s71, 14080
    v_add_u32_sdwa v65, s71, v75 dst_sel:DWORD dst_unused:UNUSED_PAD src0_sel:DWORD src1_sel:WORD_0
    s_mul_i32 s71, s68, 4576
    buffer_load_dwordx4 v135, s[8:11], s77 offen offset:3072 lds
    s_add_u32 s77, s77, s35
    v_add_u32_sdwa v66, s71, v75 dst_sel:DWORD dst_unused:UNUSED_PAD src0_sel:DWORD src1_sel:WORD_1
    ds_read_b128 v[160:163], v141 offset:0
    ds_read_b128 v[164:167], v141 offset:1024
    ds_read_b128 v[168:171], v141 offset:2048
    s_waitcnt vmcnt(8)
    s_barrier
    s_add_u32 m0, s70, 65536
    s_nop 0
    buffer_load_dwordx4 v150, s[4:7], s76 offen offset:0 lds
    s_lshl_b32 s71, s65, 2
    s_add_u32 s71, s71, s69
    s_lshl_b32 s71, s71, 8
    s_add_u32 s71, s71, 40960
    v_lshl_add_u32 v3, v0, 4, s71
    buffer_load_dwordx4 v151, s[4:7], s76 offen offset:1024 lds
    s_lshl_b32 s71, s64, 2
    s_add_u32 s71, s71, s69
    s_lshl_b32 s71, s71, 6
    s_add_u32 s71, s71, 32768
    v_lshl_add_u32 v4, v29, 12, s71
    buffer_load_dwordx4 v152, s[4:7], s76 offen offset:2048 lds
    v_bfe_u32 v2, v0, 1, 2
    v_lshl_add_u32 v4, v2, 4, v4
    v_cmp_gt_u32 vcc, 16, v0
    s_mul_i32 s36, s69, 384
    s_add_u32 s36, s36, 9216
    buffer_load_dwordx4 v153, s[4:7], s76 offen offset:3072 lds
    v_cndmask_b32 v36, v4, v3, vcc
    v_min_u32 v2, 23, v0
    v_lshl_add_u32 v37, v2, 4, s36
    v_lshrrev_b32 v154, 3, v0
    v_and_b32 v155, 7, v0
    s_add_u32 m0, s70, 98304
    s_nop 0
    buffer_load_dwordx4 v132, s[8:11], s77 offen offset:0 lds
    s_cmp_ge_u32 s77, 1376256
    s_cselect_b32 s34, -768, s50
    s_cselect_b32 s35, -1376256, s51
    s_add_u32 s76, s76, s34
    v_bfe_u32 v156, v0, 4, 2
    v_lshlrev_b32 v156, 1, v156
    v_xor_b32 v155, v155, v156
    v_mul_u32_u24 v154, 896, v154
    v_lshl_add_u32 v40, v155, 4, v154
    buffer_load_dwordx4 v133, s[8:11], s77 offen offset:1024 lds
    v_add_u32 v41, 6144, v40
    v_add_u32 v42, 12288, v40
    v_add_u32 v43, 18432, v40
    buffer_load_dwordx4 v134, s[8:11], s77 offen offset:2048 lds
    buffer_load_dwordx4 v135, s[8:11], s77 offen offset:3072 lds
    s_add_u32 s77, s77, s35
    s_waitcnt vmcnt(8)
    s_barrier
    s_add_u32 m0, s70, 16384
    s_nop 0
    buffer_load_dwordx4 v150, s[4:7], s76 offen offset:0 lds
    v_bfe_u32 v53, v0, 2, 2
    v_lshlrev_b32 v53, 7, v53
    v_and_b32 v54, 3, v0
    v_lshl_add_u32 v53, v54, 4, v53
    v_lshrrev_b32 v54, 5, v0
    buffer_load_dwordx4 v151, s[4:7], s76 offen offset:1024 lds
    v_lshl_add_u32 v53, v54, 6, v53
    v_bfe_u32 v54, v0, 4, 1
    v_lshl_add_u32 v54, v54, 9, v53
    s_lshl_b32 s74, s67, 1
    s_add_u32 s74, s74, s68
    buffer_load_dwordx4 v152, s[4:7], s76 offen offset:2048 lds
    s_lshr_b32 s71, s74, 6
    s_lshl_b32 s71, s71, 1
    s_add_u32 s71, s71, s40
    s_lshl_b32 s71, s71, 2
    s_bfe_u32 s72, s74, 0x20004
    buffer_load_dwordx4 v153, s[4:7], s76 offen offset:3072 lds
    s_add_u32 s71, s71, s72
    s_add_u32 s71, s71, 184
    s_lshl_b32 s75, s71, 7
    s_lshl_b32 s74, s74, 12
    s_add_u32 s74, s74, 3145728
    s_add_u32 m0, s70, 0
    s_nop 0
    buffer_load_dwordx4 v132, s[8:11], s77 offen offset:0 lds
    s_cmp_ge_u32 s77, 1376256
    s_cselect_b32 s34, -768, s50
    s_cselect_b32 s35, -1376256, s51
    s_add_u32 s76, s76, s34
    buffer_load_dwordx4 v133, s[8:11], s77 offen offset:1024 lds
    buffer_load_dwordx4 v134, s[8:11], s77 offen offset:2048 lds
    buffer_load_dwordx4 v135, s[8:11], s77 offen offset:3072 lds
    s_add_u32 s77, s77, s35
    s_waitcnt vmcnt(8)
    s_barrier
    buffer_load_dword v116, v26, s[16:19], 0 offen sc1
    s_add_u32 m0, s70, 49152
    s_nop 0
    buffer_load_dwordx4 v150, s[4:7], s76 offen offset:0 lds
    s_waitcnt lgkmcnt(0)
    v_add_f32 v224, v224, v160
    v_add_f32 v225, v225, v161
    v_add_f32 v226, v226, v162
    v_add_f32 v227, v227, v163
    v_add_f32 v228, v228, v164
    buffer_load_dwordx4 v151, s[4:7], s76 offen offset:1024 lds
    v_add_f32 v229, v229, v165
    v_add_f32 v230, v230, v166
    v_add_f32 v231, v231, v167
    v_add_f32 v232, v232, v168
    v_add_f32 v233, v233, v169
    buffer_load_dwordx4 v152, s[4:7], s76 offen offset:2048 lds
    v_add_f32 v234, v234, v170
    v_add_f32 v235, v235, v171
    v_and_b32 v50, 31, v0
    v_lshrrev_b32 v51, 5, v0
    v_lshlrev_b32 v2, 3, v50
    buffer_load_dwordx4 v153, s[4:7], s76 offen offset:3072 lds
    v_lshl_add_u32 v2, v51, 2, v2
    v_sub_u32 v3, 2, v51
    v_lshlrev_b32 v3, v3, v50
    v_lshl_add_u32 v3, v51, 7, v3
    v_add_u32 v3, 256, v3
    s_add_u32 m0, s70, 81920
    s_nop 0
    buffer_load_dwordx4 v132, s[8:11], s77 offen offset:0 lds
    v_lshl_add_u32 v4, v51, 7, v50
    v_add_u32 v4, 512, v4
    v_lshrrev_b32 v5, 5, v2
    v_add_u32 v5, v5, v2
    v_lshl_add_u32 v22, v5, 2, s39
    buffer_load_dwordx4 v133, s[8:11], s77 offen offset:1024 lds
    v_lshrrev_b32 v5, 5, v3
    v_add_u32 v5, v5, v3
    v_lshl_add_u32 v23, v5, 2, s39
    v_lshrrev_b32 v5, 5, v4
    v_add_u32 v5, v5, v4
    buffer_load_dwordx4 v134, s[8:11], s77 offen offset:2048 lds
    v_lshl_add_u32 v25, v5, 2, s39
    v_lshl_add_u32 v24, v51, 8, v23
    buffer_load_dwordx4 v135, s[8:11], s77 offen offset:3072 lds
    s_waitcnt vmcnt(9)
    s_barrier
    s_mov_b32 s73, 0
    s_waitcnt vmcnt(8)
L_vp_19:
    v_cmp_gt_u32 vcc, 4, v116
    s_add_u32 s73, s73, 1
    s_cmp_gt_u32 s73, 1000000
    s_cbranch_scc1 L_vpo_20
    s_cbranch_vccz L_vpo_20
    s_sleep 2
    buffer_load_dword v116, v26, s[16:19], 0 offen sc1
    s_waitcnt vmcnt(0)
    s_branch L_vp_19
L_vpo_20:
    buffer_load_dwordx4 v[100:103], v27, s[16:19], s30 offen sc1
    buffer_load_dwordx4 v[104:107], v27, s[16:19], s31 offen sc1
    buffer_load_dwordx4 v[108:111], v28, s[16:19], 0 offen offset:0 sc1
    buffer_load_dwordx4 v[112:115], v28, s[16:19], 0 offen offset:64 sc1
    s_mov_b32 m0, s36
    s_mov_b64 exec, 0xffffff
    buffer_load_dwordx4 v36, s[16:19], 0 offen sc1 lds
    s_mov_b64 exec, -1
    s_add_u32 m0, s70, 65536
    s_cmp_le_u32 s43, 0
    s_cselect_b32 s34, s33, s32
    s_add_u32 s34, s34, 0
    buffer_load_dwordx4 v40, s[12:15], s34 offen lds
    buffer_load_dwordx4 v41, s[12:15], s34 offen offset:1024 lds
    buffer_load_dwordx4 v42, s[12:15], s34 offen offset:2048 lds
    buffer_load_dwordx4 v43, s[12:15], s34 offen offset:3072 lds
    s_waitcnt vmcnt(9)
    s_barrier
    s_cmp_lg_u32 s69, 0
    s_cbranch_scc1 L_wn_22
    s_branch L_pad_cvA
L_ret_cvA:
L_wn_22:
    s_cmp_lg_u32 s69, 2
    s_cbranch_scc1 L_wn_23
    s_branch L_pad_mish
L_ret_mish:
L_wn_23:
    s_waitcnt vmcnt(4)
    s_mov_b32 s73, 0
L_xp_24:
    ds_read_b128 v[144:147], v37
    v_min_u32 v116, v100, v101
    s_add_u32 s73, s73, 1
    v_min3_u32 v116, v116, v102, v103
    v_min3_u32 v116, v116, v104, v105
    v_min3_u32 v116, v116, v106, v107
    v_and_b32 v128, 0xffff0000, v100
    v_and_b32 v129, 0xffff0000, v101
    v_and_b32 v130, 0xffff0000, v102
    v_and_b32 v131, 0xffff0000, v103
    v_and_b32 v132, 0xffff0000, v104
    v_and_b32 v133, 0xffff0000, v105
    v_and_b32 v134, 0xffff0000, v106
    v_and_b32 v135, 0xffff0000, v107
    s_waitcnt lgkmcnt(0)
    v_min3_u32 v116, v116, v145, v147
    v_cmp_eq_u32 vcc, 0, v116
    s_cmp_gt_u32 s73, 1000000
    s_cbranch_scc1 L_xpo_25
    s_cbranch_vccz L_xpo_25
    buffer_load_dwordx4 v[100:103], v27, s[16:19], s30 offen sc1
    buffer_load_dwordx4 v[104:107], v27, s[16:19], s31 offen sc1
    s_mov_b32 m0, s36
    s_mov_b64 exec, 0xffffff
    buffer_load_dwordx4 v36, s[16:19], 0 offen sc1 lds
    s_mov_b64 exec, -1
    s_waitcnt vmcnt(0)
    s_branch L_xp_24
L_xpo_25:
    s_barrier
    s_setprio 3
    v_rcp_f32 v128, v128
    v_lshlrev_b32 v120, 16, v100
    v_rcp_f32 v129, v129
    v_lshlrev_b32 v121, 16, v101
    v_rcp_f32 v130, v130
    v_lshlrev_b32 v122, 16, v102
    v_rcp_f32 v131, v131
    v_lshlrev_b32 v123, 16, v103
    v_rcp_f32 v132, v132
    v_lshlrev_b32 v124, 16, v104
    v_rcp_f32 v133, v133
    v_lshlrev_b32 v125, 16, v105
    v_rcp_f32 v134, v134
    v_lshlrev_b32 v126, 16, v106
    v_rcp_f32 v135, v135
    v_lshlrev_b32 v127, 16, v107
    v_mul_f32 v120, v120, v128
    v_mul_f32 v121, v121, v129
    v_mul_f32 v122, v122, v130
    v_mul_f32 v123, v123, v131
    v_mul_f32 v124, v124, v132
    v_mul_f32 v125, v125, v133
    v_mul_f32 v126, v126, v134
    v_mul_f32 v127, v127, v135
    v_lshlrev_b32 v136, 16, v108
    v_and_b32 v137, 0xffff0000, v108
    v_lshlrev_b32 v138, 16, v109
    v_and_b32 v139, 0xffff0000, v109
    v_lshlrev_b32 v140, 16, v110
    v_and_b32 v141, 0xffff0000, v110
    v_lshlrev_b32 v142, 16, v111
    v_and_b32 v143, 0xffff0000, v111
    v_fma_f32 v136, v136, v128, -v120
    v_fma_f32 v137, v137, v129, -v121
    v_fma_f32 v138, v138, v130, -v122
    v_fma_f32 v139, v139, v131, -v123
    v_fma_f32 v140, v140, v132, -v124
    v_fma_f32 v141, v141, v133, -v125
    v_fma_f32 v142, v142, v134, -v126
    v_fma_f32 v143, v143, v135, -v127
    v_cvt_pk_bf16_f32 v108, v136, v137
    v_cvt_pk_bf16_f32 v109, v138, v139
    v_cvt_pk_bf16_f32 v110, v140, v141
    v_cvt_pk_bf16_f32 v111, v142, v143
    v_lshlrev_b32 v136, 16, v112
    v_and_b32 v137, 0xffff0000, v112
    v_lshlrev_b32 v138, 16, v113
    v_and_b32 v139, 0xffff0000, v113
    v_lshlrev_b32 v140, 16, v114
    v_and_b32 v141, 0xffff0000, v114
    v_lshlrev_b32 v142, 16, v115
    v_and_b32 v143, 0xffff0000, v115
    v_fma_f32 v136, v136, v128, -v120
    v_fma_f32 v137, v137, v129, -v121
    v_fma_f32 v138, v138, v130, -v122
    v_fma_f32 v139, v139, v131, -v123
    v_fma_f32 v140, v140, v132, -v124
    v_fma_f32 v141, v141, v133, -v125
    v_fma_f32 v142, v142, v134, -v126
    v_fma_f32 v143, v143, v135, -v127
    v_cvt_pk_bf16_f32 v112, v136, v137
    v_cvt_pk_bf16_f32 v113, v138, v139
    v_cvt_pk_bf16_f32 v114, v140, v141
    v_cvt_pk_bf16_f32 v115, v142, v143
    v_lshl_add_u32 v55, s68, 2, v34
    s_add_u32 m0, s70, 49152
    s_add_u32 s34, s42, 0
    buffer_load_dwordx4 v40, s[12:15], s34 offen lds
    buffer_load_dwordx4 v41, s[12:15], s34 offen offset:1024 lds
    buffer_load_dwordx4 v42, s[12:15], s34 offen offset:2048 lds
    buffer_load_dwordx4 v43, s[12:15], s34 offen offset:3072 lds
    s_add_u32 m0, s70, 81920
    s_add_u32 s34, s42, 28672
    buffer_load_dwordx4 v40, s[12:15], s34 offen lds
    buffer_load_dwordx4 v41, s[12:15], s34 offen offset:1024 lds
    buffer_load_dwordx4 v42, s[12:15], s34 offen offset:2048 lds
    buffer_load_dwordx4 v43, s[12:15], s34 offen offset:3072 lds
    ds_write2_b32 v22, v224, v225 offset0:0 offset1:1
    ds_write2_b32 v22, v226, v227 offset0:2 offset1:3
    ds_write2_b32 v23, v228, v229 offset0:0 offset1:1
    ds_write2_b32 v24, v230, v231 offset0:2 offset1:3
    ds_write2_b32 v25, v232, v233 offset0:0 offset1:33
    ds_write2_b32 v25, v234, v235 offset0:66 offset1:99
    s_mov_b64 exec, 1
    ds_add_u32 v55, v35 offset:16
    s_mov_b64 exec, -1
    s_mov_b32 s73, 0
L_spin_26:
    ds_read_b32 v50, v55 offset:16
    s_add_u32 s73, s73, 1
    s_waitcnt lgkmcnt(0)
    v_readfirstlane_b32 s71, v50
    s_cmp_gt_u32 s73, 30000000
    s_cbranch_scc1 L_spun_27
    s_cmp_lt_u32 s71, 2
    s_cbranch_scc1 L_spin_26
L_spun_27:
    ds_read2st64_b32 v[182:183], v19 offset1:13
    ds_read2st64_b32 v[184:185], v20 offset1:13
    ds_read2st64_b32 v[186:187], v21 offset1:13
    ds_read2st64_b32 v[160:161], v8 offset1:13
    ds_read2st64_b32 v[162:163], v9 offset1:13
    ds_read2st64_b32 v[164:165], v10 offset1:13
    ds_read2st64_b32 v[166:167], v11 offset1:13
    ds_read2st64_b32 v[168:169], v12 offset1:13
    ds_read2st64_b32 v[170:171], v13 offset1:13
    ds_read2st64_b32 v[172:173], v14 offset1:13
    ds_read2st64_b32 v[174:175], v15 offset1:13
    ds_read2st64_b32 v[176:177], v16 offset1:13
    ds_read2st64_b32 v[178:179], v17 offset1:13
    ds_read2st64_b32 v[180:181], v18 offset1:13
    ds_write_b128 v67, v[108:111] offset:0
    ds_write_b128 v67, v[112:115] offset:4576
    ds_write_b128 v48, v[30:33] offset:4096
    s_waitcnt lgkmcnt(14)
    v_add_f32 v203, v182, v183
    v_add_f32 v204, v184, v185
    v_add_f32 v205, v186, v187
    v_cmp_eq_u32 vcc, 1, v29
    s_nop 1
    v_cndmask_b32 v206, v204, v203, vcc
    v_cvt_pk_bf16_f32 v208, v204, v204
    v_cvt_pk_bf16_f32 v209, v204, v206
    v_cvt_pk_bf16_f32 v210, v203, v203
    v_cvt_pk_bf16_f32 v211, v203, v203
    ds_write_b128 v64, v[208:211] offset:0
    v_cvt_pk_bf16_f32 v212, v204, v204
    v_cvt_pk_bf16_f32 v213, v206, v203
    v_cvt_pk_bf16_f32 v214, v203, v203
    v_cvt_pk_bf16_f32 v215, v203, v203
    ds_write_b128 v64, v[212:215] offset:4160
    v_cvt_pk_bf16_f32 v216, v204, v206
    v_cvt_pk_bf16_f32 v217, v203, v203
    v_cvt_pk_bf16_f32 v218, v203, v203
    v_cvt_pk_bf16_f32 v219, v203, v203
    ds_write_b128 v64, v[216:219] offset:8320
    v_cvt_pk_bf16_f32 v220, v206, v203
    v_cvt_pk_bf16_f32 v221, v203, v203
    v_cvt_pk_bf16_f32 v222, v203, v203
    v_cvt_pk_bf16_f32 v223, v203, v205
    ds_write_b128 v64, v[220:223] offset:12480
    s_waitcnt lgkmcnt(7)
    v_add_f32 v192, v160, v161
    v_add_f32 v193, v162, v163
    v_add_f32 v194, v164, v165
    v_add_f32 v195, v166, v167
    v_add_f32 v196, v168, v169
    v_add_f32 v197, v170, v171
    v_add_f32 v198, v172, v173
    v_add_f32 v199, v174, v175
    v_add_f32 v200, v176, v177
    v_add_f32 v201, v178, v179
    v_add_f32 v202, v180, v181
    v_cvt_pk_bf16_f32 v224, v192, v193
    v_cvt_pk_bf16_f32 v225, v194, v195
    v_cvt_pk_bf16_f32 v226, v196, v197
    v_cvt_pk_bf16_f32 v227, v198, v199
    ds_write_b128 v64, v[224:227] offset:2048
    v_cvt_pk_bf16_f32 v228, v193, v194
    v_cvt_pk_bf16_f32 v229, v195, v196
    v_cvt_pk_bf16_f32 v230, v197, v198
    v_cvt_pk_bf16_f32 v231, v199, v200
    ds_write_b128 v64, v[228:231] offset:6208
    v_cvt_pk_bf16_f32 v232, v194, v195
    v_cvt_pk_bf16_f32 v233, v196, v197
    v_cvt_pk_bf16_f32 v234, v198, v199
    v_cvt_pk_bf16_f32 v235, v200, v201
    ds_write_b128 v64, v[232:235] offset:10368
    v_cvt_pk_bf16_f32 v236, v195, v196
    v_cvt_pk_bf16_f32 v237, v197, v198
    v_cvt_pk_bf16_f32 v238, v199, v200
    v_cvt_pk_bf16_f32 v239, v201, v202
    ds_write_b128 v64, v[236:239] offset:14528
    s_waitcnt vmcnt(0) lgkmcnt(0)
    s_barrier
    s_branch L_cvA
    .p2align 12
L_pad_cvA:
    s_branch L_ret_cvA
L_cvA:
    ds_read_b64 v[100:101], v65 offset:4032
    ds_read_b64 v[102:103], v65 offset:4040
    ds_read_b128 v[132:135], v66 offset:192
    ds_read_b64 v[104:105], v65 offset:3520
    ds_read_b64 v[106:107], v65 offset:3528
    ds_read_b128 v[136:139], v66 offset:704
    ds_read_b64 v[108:109], v65 offset:3008
    ds_read_b64 v[110:111], v65 offset:3016
    ds_read_b128 v[140:143], v66 offset:1216
    ds_read_b64 v[112:113], v65 offset:2496
    ds_read_b64 v[114:115], v65 offset:2504
    ds_read_b128 v[144:147], v66 offset:1728
    s_setprio 2
    s_waitcnt lgkmcnt(10)
    s_waitcnt lgkmcnt(9)
    v_mfma_f32_16x16x32_bf16 v[68:71], v[100:103], v[132:135], 0
    ds_read_b64 v[116:117], v65 offset:1984
    ds_read_b64 v[118:119], v65 offset:1992
    s_waitcnt lgkmcnt(9)
    v_mfma_f32_16x16x32_bf16 v[72:75], v[104:107], v[132:135], 0
    ds_read_b128 v[148:151], v66 offset:2240
    s_waitcnt lgkmcnt(9)
    v_mfma_f32_16x16x32_bf16 v[72:75], v[100:103], v[136:139], v[72:75]
    ds_read_b64 v[120:121], v65 offset:1472
    v_mfma_f32_16x16x32_bf16 v[76:79], v[104:107], v[136:139], 0
    ds_read_b64 v[122:123], v65 offset:1480
    s_waitcnt lgkmcnt(9)
    v_mfma_f32_16x16x32_bf16 v[76:79], v[108:111], v[132:135], v[76:79]
    ds_read_b128 v[152:155], v66 offset:2752
    s_waitcnt lgkmcnt(9)
    v_mfma_f32_16x16x32_bf16 v[76:79], v[100:103], v[140:143], v[76:79]
    ds_read_b64 v[124:125], v65 offset:960
    v_mfma_f32_16x16x32_bf16 v[80:83], v[108:111], v[136:139], 0
    ds_read_b64 v[126:127], v65 offset:968
    v_mfma_f32_16x16x32_bf16 v[80:83], v[104:107], v[140:143], v[80:83]
    ds_read_b128 v[156:159], v66 offset:3264
    v_mfma_f32_16x16x32_bf16 v[84:87], v[108:111], v[140:143], 0
    ds_read_b64 v[128:129], v65 offset:448
    s_waitcnt lgkmcnt(11)
    v_mfma_f32_16x16x32_bf16 v[80:83], v[112:115], v[132:135], v[80:83]
    ds_read_b64 v[130:131], v65 offset:456
    s_waitcnt lgkmcnt(11)
    v_mfma_f32_16x16x32_bf16 v[80:83], v[100:103], v[144:147], v[80:83]
    ds_read_b128 v[160:163], v66 offset:3776
    v_mfma_f32_16x16x32_bf16 v[84:87], v[112:115], v[136:139], v[84:87]
    ds_read_b64 v[164:165], v65 offset:3968
    ds_read_b64 v[166:167], v65 offset:3976
    v_mfma_f32_16x16x32_bf16 v[84:87], v[104:107], v[144:147], v[84:87]
    ds_read_b128 v[196:199], v66 offset:128
    v_mfma_f32_16x16x32_bf16 v[88:91], v[112:115], v[140:143], 0
    ds_read_b64 v[168:169], v65 offset:3456
    v_mfma_f32_16x16x32_bf16 v[88:91], v[108:111], v[144:147], v[88:91]
    ds_read_b64 v[170:171], v65 offset:3464
    v_mfma_f32_16x16x32_bf16 v[92:95], v[112:115], v[144:147], 0
    ds_read_b128 v[200:203], v66 offset:640
    s_waitcnt lgkmcnt(15)
    v_mfma_f32_16x16x32_bf16 v[84:87], v[116:119], v[132:135], v[84:87]
    ds_read_b64 v[172:173], v65 offset:2944
    v_mfma_f32_16x16x32_bf16 v[84:87], v[100:103], v[148:151], v[84:87]
    ds_read_b64 v[174:175], v65 offset:2952
    v_mfma_f32_16x16x32_bf16 v[88:91], v[116:119], v[136:139], v[88:91]
    ds_read_b128 v[204:207], v66 offset:1152
    v_mfma_f32_16x16x32_bf16 v[88:91], v[104:107], v[148:151], v[88:91]
    ds_read_b64 v[176:177], v65 offset:2432
    v_mfma_f32_16x16x32_bf16 v[92:95], v[116:119], v[140:143], v[92:95]
    ds_read_b64 v[178:179], v65 offset:2440
    v_mfma_f32_16x16x32_bf16 v[92:95], v[108:111], v[148:151], v[92:95]
    ds_read_b128 v[208:211], v66 offset:1664
    v_mfma_f32_16x16x32_bf16 v[96:99], v[116:119], v[144:147], 0
    ds_read_b64 v[180:181], v65 offset:1920
    ds_read_b64 v[182:183], v65 offset:1928
    v_mfma_f32_16x16x32_bf16 v[96:99], v[112:115], v[148:151], v[96:99]
    ds_read_b128 v[212:215], v66 offset:2176
    s_waitcnt lgkmcnt(15)
    v_mfma_f32_16x16x32_bf16 v[88:91], v[120:123], v[132:135], v[88:91]
    ds_read_b64 v[184:185], v65 offset:1408
    v_mfma_f32_16x16x32_bf16 v[88:91], v[100:103], v[152:155], v[88:91]
    ds_read_b64 v[186:187], v65 offset:1416
    v_mfma_f32_16x16x32_bf16 v[92:95], v[120:123], v[136:139], v[92:95]
    ds_read_b128 v[216:219], v66 offset:2688
    v_mfma_f32_16x16x32_bf16 v[92:95], v[104:107], v[152:155], v[92:95]
    ds_read_b64 v[188:189], v65 offset:896
    v_mfma_f32_16x16x32_bf16 v[96:99], v[120:123], v[140:143], v[96:99]
    ds_read_b64 v[190:191], v65 offset:904
    v_mfma_f32_16x16x32_bf16 v[96:99], v[108:111], v[152:155], v[96:99]
    ds_read_b128 v[220:223], v66 offset:3200
    v_mfma_f32_16x16x32_bf16 v[92:95], v[124:127], v[132:135], v[92:95]
    ds_read_b64 v[192:193], v65 offset:384
    v_mfma_f32_16x16x32_bf16 v[92:95], v[100:103], v[156:159], v[92:95]
    ds_read_b64 v[194:195], v65 offset:392
    v_mfma_f32_16x16x32_bf16 v[96:99], v[124:127], v[136:139], v[96:99]
    ds_read_b128 v[224:227], v66 offset:3712
    v_mfma_f32_16x16x32_bf16 v[96:99], v[104:107], v[156:159], v[96:99]
    v_mfma_f32_16x16x32_bf16 v[96:99], v[128:131], v[132:135], v[96:99]
    v_mfma_f32_16x16x32_bf16 v[96:99], v[100:103], v[160:163], v[96:99]
    s_waitcnt lgkmcnt(0)
    v_mfma_f32_16x16x32_bf16 v[68:71], v[164:167], v[196:199], v[68:71]
    ds_read_b64 v[100:101], v65 offset:3904
    v_mfma_f32_16x16x32_bf16 v[72:75], v[168:171], v[196:199], v[72:75]
    ds_read_b64 v[102:103], v65 offset:3912
    v_mfma_f32_16x16x32_bf16 v[72:75], v[164:167], v[200:203], v[72:75]
    ds_read_b128 v[132:135], v66 offset:64
    v_mfma_f32_16x16x32_bf16 v[76:79], v[168:171], v[200:203], v[76:79]
    ds_read_b64 v[104:105], v65 offset:3392
    v_mfma_f32_16x16x32_bf16 v[76:79], v[172:175], v[196:199], v[76:79]
    ds_read_b64 v[106:107], v65 offset:3400
    v_mfma_f32_16x16x32_bf16 v[76:79], v[164:167], v[204:207], v[76:79]
    ds_read_b128 v[136:139], v66 offset:576
    v_mfma_f32_16x16x32_bf16 v[80:83], v[172:175], v[200:203], v[80:83]
    ds_read_b64 v[108:109], v65 offset:2880
    v_mfma_f32_16x16x32_bf16 v[80:83], v[168:171], v[204:207], v[80:83]
    ds_read_b64 v[110:111], v65 offset:2888
    v_mfma_f32_16x16x32_bf16 v[84:87], v[172:175], v[204:207], v[84:87]
    ds_read_b128 v[140:143], v66 offset:1088
    v_mfma_f32_16x16x32_bf16 v[80:83], v[176:179], v[196:199], v[80:83]
    ds_read_b64 v[112:113], v65 offset:2368
    v_mfma_f32_16x16x32_bf16 v[80:83], v[164:167], v[208:211], v[80:83]
    ds_read_b64 v[114:115], v65 offset:2376
    v_mfma_f32_16x16x32_bf16 v[84:87], v[176:179], v[200:203], v[84:87]
    ds_read_b128 v[144:147], v66 offset:1600
    v_mfma_f32_16x16x32_bf16 v[84:87], v[168:171], v[208:211], v[84:87]
    ds_read_b64 v[116:117], v65 offset:1856
    v_mfma_f32_16x16x32_bf16 v[88:91], v[176:179], v[204:207], v[88:91]
    ds_read_b64 v[118:119], v65 offset:1864
    v_mfma_f32_16x16x32_bf16 v[88:91], v[172:175], v[208:211], v[88:91]
    ds_read_b128 v[148:151], v66 offset:2112
    v_mfma_f32_16x16x32_bf16 v[92:95], v[176:179], v[208:211], v[92:95]
    ds_read_b64 v[120:121], v65 offset:1344
    v_mfma_f32_16x16x32_bf16 v[84:87], v[180:183], v[196:199], v[84:87]
    ds_read_b64 v[122:123], v65 offset:1352
    v_mfma_f32_16x16x32_bf16 v[84:87], v[164:167], v[212:215], v[84:87]
    ds_read_b128 v[152:155], v66 offset:2624
    v_mfma_f32_16x16x32_bf16 v[88:91], v[180:183], v[200:203], v[88:91]
    ds_read_b64 v[124:125], v65 offset:832
    v_mfma_f32_16x16x32_bf16 v[88:91], v[168:171], v[212:215], v[88:91]
    ds_read_b64 v[126:127], v65 offset:840
    v_mfma_f32_16x16x32_bf16 v[92:95], v[180:183], v[204:207], v[92:95]
    ds_read_b128 v[156:159], v66 offset:3136
    v_mfma_f32_16x16x32_bf16 v[92:95], v[172:175], v[212:215], v[92:95]
    ds_read_b64 v[128:129], v65 offset:320
    v_mfma_f32_16x16x32_bf16 v[96:99], v[180:183], v[208:211], v[96:99]
    ds_read_b64 v[130:131], v65 offset:328
    v_mfma_f32_16x16x32_bf16 v[96:99], v[176:179], v[212:215], v[96:99]
    ds_read_b128 v[160:163], v66 offset:3648
    v_mfma_f32_16x16x32_bf16 v[88:91], v[184:187], v[196:199], v[88:91]
    v_mfma_f32_16x16x32_bf16 v[88:91], v[164:167], v[216:219], v[88:91]
    v_mfma_f32_16x16x32_bf16 v[92:95], v[184:187], v[200:203], v[92:95]
    v_mfma_f32_16x16x32_bf16 v[92:95], v[168:171], v[216:219], v[92:95]
    v_mfma_f32_16x16x32_bf16 v[96:99], v[184:187], v[204:207], v[96:99]
    v_mfma_f32_16x16x32_bf16 v[96:99], v[172:175], v[216:219], v[96:99]
    v_mfma_f32_16x16x32_bf16 v[92:95], v[188:191], v[196:199], v[92:95]
    v_mfma_f32_16x16x32_bf16 v[92:95], v[164:167], v[220:223], v[92:95]
    v_mfma_f32_16x16x32_bf16 v[96:99], v[188:191], v[200:203], v[96:99]
    v_mfma_f32_16x16x32_bf16 v[96:99], v[168:171], v[220:223], v[96:99]
    v_mfma_f32_16x16x32_bf16 v[96:99], v[192:195], v[196:199], v[96:99]
    v_mfma_f32_16x16x32_bf16 v[96:99], v[164:167], v[224:227], v[96:99]
    s_waitcnt lgkmcnt(0)
    v_mfma_f32_16x16x32_bf16 v[68:71], v[100:103], v[132:135], v[68:71]
    ds_read_b64 v[164:165], v65 offset:3840
    v_mfma_f32_16x16x32_bf16 v[72:75], v[104:107], v[132:135], v[72:75]
    ds_read_b64 v[166:167], v65 offset:3848
    v_mfma_f32_16x16x32_bf16 v[72:75], v[100:103], v[136:139], v[72:75]
    ds_read_b128 v[196:199], v66 offset:0
    v_mfma_f32_16x16x32_bf16 v[76:79], v[104:107], v[136:139], v[76:79]
    ds_read_b64 v[168:169], v65 offset:3328
    v_mfma_f32_16x16x32_bf16 v[76:79], v[108:111], v[132:135], v[76:79]
    ds_read_b64 v[170:171], v65 offset:3336
    v_mfma_f32_16x16x32_bf16 v[76:79], v[100:103], v[140:143], v[76:79]
    ds_read_b128 v[200:203], v66 offset:512
    v_mfma_f32_16x16x32_bf16 v[80:83], v[108:111], v[136:139], v[80:83]
    ds_read_b64 v[172:173], v65 offset:2816
    v_mfma_f32_16x16x32_bf16 v[80:83], v[104:107], v[140:143], v[80:83]
    ds_read_b64 v[174:175], v65 offset:2824
    v_mfma_f32_16x16x32_bf16 v[84:87], v[108:111], v[140:143], v[84:87]
    ds_read_b128 v[204:207], v66 offset:1024
    v_mfma_f32_16x16x32_bf16 v[80:83], v[112:115], v[132:135], v[80:83]
    ds_read_b64 v[176:177], v65 offset:2304
    v_mfma_f32_16x16x32_bf16 v[80:83], v[100:103], v[144:147], v[80:83]
    ds_read_b64 v[178:179], v65 offset:2312
    v_mfma_f32_16x16x32_bf16 v[84:87], v[112:115], v[136:139], v[84:87]
    ds_read_b128 v[208:211], v66 offset:1536
    v_mfma_f32_16x16x32_bf16 v[84:87], v[104:107], v[144:147], v[84:87]
    ds_read_b64 v[180:181], v65 offset:1792
    v_mfma_f32_16x16x32_bf16 v[88:91], v[112:115], v[140:143], v[88:91]
    ds_read_b64 v[182:183], v65 offset:1800
    v_mfma_f32_16x16x32_bf16 v[88:91], v[108:111], v[144:147], v[88:91]
    ds_read_b128 v[212:215], v66 offset:2048
    v_mfma_f32_16x16x32_bf16 v[92:95], v[112:115], v[144:147], v[92:95]
    ds_read_b64 v[184:185], v65 offset:1280
    v_mfma_f32_16x16x32_bf16 v[84:87], v[116:119], v[132:135], v[84:87]
    ds_read_b64 v[186:187], v65 offset:1288
    v_mfma_f32_16x16x32_bf16 v[84:87], v[100:103], v[148:151], v[84:87]
    ds_read_b128 v[216:219], v66 offset:2560
    v_mfma_f32_16x16x32_bf16 v[88:91], v[116:119], v[136:139], v[88:91]
    ds_read_b64 v[188:189], v65 offset:768
    v_mfma_f32_16x16x32_bf16 v[88:91], v[104:107], v[148:151], v[88:91]
    ds_read_b64 v[190:191], v65 offset:776
    v_mfma_f32_16x16x32_bf16 v[92:95], v[116:119], v[140:143], v[92:95]
    ds_read_b128 v[220:223], v66 offset:3072
    v_mfma_f32_16x16x32_bf16 v[92:95], v[108:111], v[148:151], v[92:95]
    ds_read_b64 v[192:193], v65 offset:256
    v_mfma_f32_16x16x32_bf16 v[96:99], v[116:119], v[144:147], v[96:99]
    ds_read_b64 v[194:195], v65 offset:264
    v_mfma_f32_16x16x32_bf16 v[96:99], v[112:115], v[148:151], v[96:99]
    ds_read_b128 v[224:227], v66 offset:3584
    v_mfma_f32_16x16x32_bf16 v[88:91], v[120:123], v[132:135], v[88:91]
    v_mfma_f32_16x16x32_bf16 v[88:91], v[100:103], v[152:155], v[88:91]
    v_mfma_f32_16x16x32_bf16 v[92:95], v[120:123], v[136:139], v[92:95]
    v_mfma_f32_16x16x32_bf16 v[92:95], v[104:107], v[152:155], v[92:95]
    v_mfma_f32_16x16x32_bf16 v[96:99], v[120:123], v[140:143], v[96:99]
    v_mfma_f32_16x16x32_bf16 v[96:99], v[108:111], v[152:155], v[96:99]
    v_mfma_f32_16x16x32_bf16 v[92:95], v[124:127], v[132:135], v[92:95]
    v_mfma_f32_16x16x32_bf16 v[92:95], v[100:103], v[156:159], v[92:95]
    v_mfma_f32_16x16x32_bf16 v[96:99], v[124:127], v[136:139], v[96:99]
    v_mfma_f32_16x16x32_bf16 v[96:99], v[104:107], v[156:159], v[96:99]
    v_mfma_f32_16x16x32_bf16 v[96:99], v[128:131], v[132:135], v[96:99]
    v_mfma_f32_16x16x32_bf16 v[96:99], v[100:103], v[160:163], v[96:99]
    s_waitcnt lgkmcnt(0)
    s_mov_b64 exec, 1
    ds_add_u32 v34, v35 offset:8
    s_mov_b64 exec, -1
    s_cmp_eq_u32 s40, 1
    s_cbranch_scc1 L_h1_28
    v_mfma_f32_16x16x32_bf16 v[72:75], v[164:167], v[200:203], v[72:75]
    s_lshl_b32 s71, s69, 12
    v_mfma_f32_16x16x32_bf16 v[72:75], v[168:171], v[196:199], v[72:75]
    s_add_u32 s71, s71, 16384
    v_mfma_f32_16x16x32_bf16 v[76:79], v[164:167], v[204:207], v[76:79]
    v_lshl_add_u32 v51, v0, 4, s71
    v_mfma_f32_16x16x32_bf16 v[76:79], v[168:171], v[200:203], v[76:79]
    ds_read_b32 v50, v34 offset:8
    v_mfma_f32_16x16x32_bf16 v[76:79], v[172:175], v[196:199], v[76:79]
    v_xor_b32 v52, 0x1000, v51
    v_mfma_f32_16x16x32_bf16 v[88:91], v[164:167], v[216:219], v[88:91]
    v_bfe_u32 v56, v0, 4, 1
    v_mfma_f32_16x16x32_bf16 v[88:91], v[168:171], v[212:215], v[88:91]
    v_mul_u32_u24 v56, 3584, v56
    v_mfma_f32_16x16x32_bf16 v[88:91], v[172:175], v[208:211], v[88:91]
    v_add_u32 v56, v56, v53
    v_mfma_f32_16x16x32_bf16 v[88:91], v[176:179], v[204:207], v[88:91]
    v_mfma_f32_16x16x32_bf16 v[88:91], v[180:183], v[200:203], v[88:91]
    v_mfma_f32_16x16x32_bf16 v[88:91], v[184:187], v[196:199], v[88:91]
    s_waitcnt lgkmcnt(0)
    v_readfirstlane_b32 s71, v50
    s_cmp_ge_u32 s71, 4
    s_cbranch_scc1 L_ck_30
    s_mov_b32 s73, 0
L_spin_31:
    ds_read_b32 v50, v34 offset:8
    s_add_u32 s73, s73, 1
    s_waitcnt lgkmcnt(0)
    v_readfirstlane_b32 s71, v50
    s_cmp_gt_u32 s73, 30000000
    s_cbranch_scc1 L_spun_32
    s_cmp_lt_u32 s71, 4
    s_cbranch_scc1 L_spin_31
L_spun_32:
L_ck_30:
    v_mfma_f32_16x16x32_bf16 v[92:95], v[164:167], v[220:223], v[92:95]
    ds_write_b128 v51, v[72:75] offset:0
    v_mfma_f32_16x16x32_bf16 v[92:95], v[168:171], v[216:219], v[92:95]
    v_mfma_f32_16x16x32_bf16 v[92:95], v[172:175], v[212:215], v[92:95]
    v_mfma_f32_16x16x32_bf16 v[92:95], v[176:179], v[208:211], v[92:95]
    ds_write_b128 v51, v[76:79] offset:1024
    v_mfma_f32_16x16x32_bf16 v[92:95], v[180:183], v[204:207], v[92:95]
    v_mfma_f32_16x16x32_bf16 v[92:95], v[184:187], v[200:203], v[92:95]
    v_mfma_f32_16x16x32_bf16 v[92:95], v[188:191], v[196:199], v[92:95]
    v_mfma_f32_16x16x32_bf16 v[96:99], v[164:167], v[224:227], v[96:99]
    v_mfma_f32_16x16x32_bf16 v[96:99], v[168:171], v[220:223], v[96:99]
    ds_write_b128 v51, v[88:91] offset:2048
    v_mfma_f32_16x16x32_bf16 v[96:99], v[172:175], v[216:219], v[96:99]
    v_mfma_f32_16x16x32_bf16 v[96:99], v[176:179], v[212:215], v[96:99]
    v_mfma_f32_16x16x32_bf16 v[96:99], v[180:183], v[208:211], v[96:99]
    v_mfma_f32_16x16x32_bf16 v[96:99], v[184:187], v[204:207], v[96:99]
    v_mfma_f32_16x16x32_bf16 v[96:99], v[188:191], v[200:203], v[96:99]
    ds_write_b128 v51, v[92:95] offset:3072
    s_mov_b64 exec, 1
    ds_add_u32 v55, v35 offset:16
    s_mov_b64 exec, -1
    v_mfma_f32_16x16x32_bf16 v[96:99], v[192:195], v[196:199], v[96:99]
    v_mfma_f32_16x16x32_bf16 v[84:87], v[164:167], v[212:215], v[84:87]
    v_mfma_f32_16x16x32_bf16 v[84:87], v[168:171], v[208:211], v[84:87]
    v_mfma_f32_16x16x32_bf16 v[84:87], v[172:175], v[204:207], v[84:87]
    v_mfma_f32_16x16x32_bf16 v[84:87], v[176:179], v[200:203], v[84:87]
    v_mfma_f32_16x16x32_bf16 v[84:87], v[180:183], v[196:199], v[84:87]
    v_mfma_f32_16x16x32_bf16 v[80:83], v[164:167], v[208:211], v[80:83]
    ds_read_b32 v50, v55 offset:16
    v_mfma_f32_16x16x32_bf16 v[80:83], v[168:171], v[204:207], v[80:83]
    v_mfma_f32_16x16x32_bf16 v[80:83], v[172:175], v[200:203], v[80:83]
    v_mfma_f32_16x16x32_bf16 v[80:83], v[176:179], v[196:199], v[80:83]
    v_mfma_f32_16x16x32_bf16 v[68:71], v[164:167], v[196:199], v[68:71]
    s_setprio 3
    s_waitcnt lgkmcnt(0)
    v_readfirstlane_b32 s71, v50
    s_cmp_ge_u32 s71, 4
    s_cbranch_scc1 L_ck_33
    s_mov_b32 s73, 0
L_spin_34:
    ds_read_b32 v50, v55 offset:16
    s_add_u32 s73, s73, 1
    s_waitcnt lgkmcnt(0)
    v_readfirstlane_b32 s71, v50
    s_cmp_gt_u32 s73, 30000000
    s_cbranch_scc1 L_spun_35
    s_cmp_lt_u32 s71, 4
    s_cbranch_scc1 L_spin_34
L_spun_35:
L_ck_33:
    ds_read_b128 v[112:115], v52 offset:1024
    ds_read_b128 v[116:119], v52 offset:2048
    ds_read_b128 v[100:103], v52 offset:0
    ds_read_b128 v[128:131], v52 offset:3072
    s_waitcnt lgkmcnt(3)
    v_add_f32 v80, v80, v112
    v_add_f32 v81, v81, v113
    v_add_f32 v82, v82, v114
    v_add_f32 v83, v83, v115
    v_cvt_pk_bf16_f32 v228, v80, v81
    v_cvt_pk_bf16_f32 v229, v82, v83
    s_waitcnt lgkmcnt(2)
    v_add_f32 v84, v84, v116
    v_add_f32 v85, v85, v117
    v_add_f32 v86, v86, v118
    v_add_f32 v87, v87, v119
    v_cvt_pk_bf16_f32 v230, v84, v85
    v_cvt_pk_bf16_f32 v231, v86, v87
    s_nop 0
    v_permlane16_swap_b32 v228, v230
    v_permlane16_swap_b32 v229, v231
    buffer_store_dwordx4 v[228:231], v54, s[16:19], s74 offen offset:1536 sc1
    s_waitcnt lgkmcnt(1)
    v_add_f32 v68, v68, v100
    v_add_f32 v69, v69, v101
    v_add_f32 v70, v70, v102
    v_add_f32 v71, v71, v103
    v_cvt_pk_bf16_f32 v232, v68, v69
    v_cvt_pk_bf16_f32 v233, v70, v71
    s_waitcnt lgkmcnt(0)
    v_add_f32 v96, v96, v128
    v_add_f32 v97, v97, v129
    v_add_f32 v98, v98, v130
    v_add_f32 v99, v99, v131
    v_cvt_pk_bf16_f32 v234, v96, v97
    v_cvt_pk_bf16_f32 v235, v98, v99
    s_nop 0
    v_permlane16_swap_b32 v232, v234
    v_permlane16_swap_b32 v233, v235
    buffer_store_dwordx4 v[232:235], v56, s[16:19], s74 offen offset:0 sc1
    s_branch L_hj_29
L_h1_28:
    v_mfma_f32_16x16x32_bf16 v[68:71], v[164:167], v[196:199], v[68:71]
    s_lshl_b32 s71, s69, 12
    v_mfma_f32_16x16x32_bf16 v[80:83], v[164:167], v[208:211], v[80:83]
    s_add_u32 s71, s71, 16384
    v_mfma_f32_16x16x32_bf16 v[80:83], v[168:171], v[204:207], v[80:83]
    v_lshl_add_u32 v51, v0, 4, s71
    v_mfma_f32_16x16x32_bf16 v[80:83], v[172:175], v[200:203], v[80:83]
    ds_read_b32 v50, v34 offset:8
    v_mfma_f32_16x16x32_bf16 v[80:83], v[176:179], v[196:199], v[80:83]
    v_xor_b32 v52, 0x1000, v51
    v_mfma_f32_16x16x32_bf16 v[84:87], v[164:167], v[212:215], v[84:87]
    v_mfma_f32_16x16x32_bf16 v[84:87], v[168:171], v[208:211], v[84:87]
    v_mfma_f32_16x16x32_bf16 v[84:87], v[172:175], v[204:207], v[84:87]
    v_mfma_f32_16x16x32_bf16 v[84:87], v[176:179], v[200:203], v[84:87]
    v_mfma_f32_16x16x32_bf16 v[84:87], v[180:183], v[196:199], v[84:87]
    v_mfma_f32_16x16x32_bf16 v[96:99], v[164:167], v[224:227], v[96:99]
    s_waitcnt lgkmcnt(0)
    v_readfirstlane_b32 s71, v50
    s_cmp_ge_u32 s71, 4
    s_cbranch_scc1 L_ck_36
    s_mov_b32 s73, 0
L_spin_37:
    ds_read_b32 v50, v34 offset:8
    s_add_u32 s73, s73, 1
    s_waitcnt lgkmcnt(0)
    v_readfirstlane_b32 s71, v50
    s_cmp_gt_u32 s73, 30000000
    s_cbranch_scc1 L_spun_38
    s_cmp_lt_u32 s71, 4
    s_cbranch_scc1 L_spin_37
L_spun_38:
L_ck_36:
    v_mfma_f32_16x16x32_bf16 v[96:99], v[168:171], v[220:223], v[96:99]
    ds_write_b128 v51, v[68:71] offset:0
    v_mfma_f32_16x16x32_bf16 v[96:99], v[172:175], v[216:219], v[96:99]
    v_mfma_f32_16x16x32_bf16 v[96:99], v[176:179], v[212:215], v[96:99]
    v_mfma_f32_16x16x32_bf16 v[96:99], v[180:183], v[208:211], v[96:99]
    ds_write_b128 v51, v[80:83] offset:1024
    v_mfma_f32_16x16x32_bf16 v[96:99], v[184:187], v[204:207], v[96:99]
    v_mfma_f32_16x16x32_bf16 v[96:99], v[188:191], v[200:203], v[96:99]
    v_mfma_f32_16x16x32_bf16 v[96:99], v[192:195], v[196:199], v[96:99]
    v_mfma_f32_16x16x32_bf16 v[92:95], v[164:167], v[220:223], v[92:95]
    v_mfma_f32_16x16x32_bf16 v[92:95], v[168:171], v[216:219], v[92:95]
    ds_write_b128 v51, v[84:87] offset:2048
    v_mfma_f32_16x16x32_bf16 v[92:95], v[172:175], v[212:215], v[92:95]
    v_mfma_f32_16x16x32_bf16 v[92:95], v[176:179], v[208:211], v[92:95]
    v_mfma_f32_16x16x32_bf16 v[92:95], v[180:183], v[204:207], v[92:95]
    v_mfma_f32_16x16x32_bf16 v[92:95], v[184:187], v[200:203], v[92:95]
    v_mfma_f32_16x16x32_bf16 v[92:95], v[188:191], v[196:199], v[92:95]
    ds_write_b128 v51, v[96:99] offset:3072
    s_mov_b64 exec, 1
    ds_add_u32 v55, v35 offset:16
    s_mov_b64 exec, -1
    v_mfma_f32_16x16x32_bf16 v[88:91], v[164:167], v[216:219], v[88:91]
    v_mfma_f32_16x16x32_bf16 v[88:91], v[168:171], v[212:215], v[88:91]
    v_mfma_f32_16x16x32_bf16 v[88:91], v[172:175], v[208:211], v[88:91]
    v_mfma_f32_16x16x32_bf16 v[88:91], v[176:179], v[204:207], v[88:91]
    v_mfma_f32_16x16x32_bf16 v[88:91], v[180:183], v[200:203], v[88:91]
    v_mfma_f32_16x16x32_bf16 v[88:91], v[184:187], v[196:199], v[88:91]
    v_mfma_f32_16x16x32_bf16 v[76:79], v[164:167], v[204:207], v[76:79]
    ds_read_b32 v50, v55 offset:16
    v_mfma_f32_16x16x32_bf16 v[76:79], v[168:171], v[200:203], v[76:79]
    v_mfma_f32_16x16x32_bf16 v[76:79], v[172:175], v[196:199], v[76:79]
    v_mfma_f32_16x16x32_bf16 v[72:75], v[164:167], v[200:203], v[72:75]
    v_mfma_f32_16x16x32_bf16 v[72:75], v[168:171], v[196:199], v[72:75]
    s_setprio 3
    s_waitcnt lgkmcnt(0)
    v_readfirstlane_b32 s71, v50
    s_cmp_ge_u32 s71, 4
    s_cbranch_scc1 L_ck_39
    s_mov_b32 s73, 0
L_spin_40:
    ds_read_b32 v50, v55 offset:16
    s_add_u32 s73, s73, 1
    s_waitcnt lgkmcnt(0)
    v_readfirstlane_b32 s71, v50
    s_cmp_gt_u32 s73, 30000000
    s_cbranch_scc1 L_spun_41
    s_cmp_lt_u32 s71, 4
    s_cbranch_scc1 L_spin_40
L_spun_41:
L_ck_39:
    ds_read_b128 v[104:107], v52 offset:0
    ds_read_b128 v[108:111], v52 offset:1024
    ds_read_b128 v[120:123], v52 offset:2048
    ds_read_b128 v[124:127], v52 offset:3072
    s_waitcnt lgkmcnt(3)
    v_add_f32 v72, v72, v104
    v_add_f32 v73, v73, v105
    v_add_f32 v74, v74, v106
    v_add_f32 v75, v75, v107
    v_cvt_pk_bf16_f32 v228, v72, v73
    v_cvt_pk_bf16_f32 v229, v74, v75
    s_waitcnt lgkmcnt(2)
    v_add_f32 v76, v76, v108
    v_add_f32 v77, v77, v109
    v_add_f32 v78, v78, v110
    v_add_f32 v79, v79, v111
    v_cvt_pk_bf16_f32 v230, v76, v77
    v_cvt_pk_bf16_f32 v231, v78, v79
    s_nop 0
    v_permlane16_swap_b32 v228, v230
    v_permlane16_swap_b32 v229, v231
    buffer_store_dwordx4 v[228:231], v54, s[16:19], s74 offen offset:512 sc1
    s_waitcnt lgkmcnt(1)
    v_add_f32 v88, v88, v120
    v_add_f32 v89, v89, v121
    v_add_f32 v90, v90, v122
    v_add_f32 v91, v91, v123
    v_cvt_pk_bf16_f32 v232, v88, v89
    v_cvt_pk_bf16_f32 v233, v90, v91
    s_waitcnt lgkmcnt(0)
    v_add_f32 v92, v92, v124
    v_add_f32 v93, v93, v125
    v_add_f32 v94, v94, v126
    v_add_f32 v95, v95, v127
    v_cvt_pk_bf16_f32 v234, v92, v93
    v_cvt_pk_bf16_f32 v235, v94, v95
    s_nop 0
    v_permlane16_swap_b32 v232, v234
    v_permlane16_swap_b32 v233, v235
    buffer_store_dwordx4 v[232:235], v54, s[16:19], s74 offen offset:2560 sc1
L_hj_29:
    s_branch L_epi
    .p2align 12
L_pad_epi:
L_epi:
    s_lshl1_add_u32 s64, s64, s61
    s_mov_b32 s63, s66
    v_lshrrev_b32 v50, 1, v0
    v_mul_u32_u24 v52, 896, v50
    v_lshl_add_u32 v64, v29, 4, v52
    s_mul_i32 s41, s64, 57344
    s_lshl2_add_u32 s71, s63, s69
    s_lshl_b32 s71, s71, 5
    s_add_u32 s41, s41, s71
    s_add_u32 s66, s41, 28672
    v_lshl_add_u32 v51, s69, 1, v29
    v_and_b32 v55, 15, v50
    v_lshlrev_b32 v52, 1, v51
    v_xor_b32 v52, v52, v55
    v_lshlrev_b32 v52, 4, v52
    v_lshl_add_u32 v52, v55, 8, v52
    v_lshrrev_b32 v55, 5, v0
    v_lshl_add_u32 v52, v55, 14, v52
    v_add_u32 v68, 49152, v52
    v_xor_b32 v69, 16, v68
    v_bfe_u32 v52, v0, 4, 1
    v_lshl_add_u32 v52, v52, 2, v55
    v_xor_b32 v52, v52, v51
    v_lshlrev_b32 v52, 4, v52
    v_lshl_add_u32 v52, v51, 10, v52
    v_and_b32 v55, 14, v0
    v_add_u32 v70, v55, v52
    v_xor_b32 v71, 32, v70
    v_lshrrev_b32 v50, 3, v0
    v_and_b32 v51, 7, v0
    s_lshl_b32 s71, s69, 1
    v_xor_b32 v56, s71, v51
    v_lshlrev_b32 v56, 4, v56
    v_lshl_add_u32 v56, v50, 12, v56
    v_xor_b32 v57, 16, v56
    v_add_u32 v57, 31744, v57
    s_waitcnt vmcnt(0)
    s_mov_b32 s39, 1
    s_atomic_add s39, s[58:59], s75
    v_lshlrev_b32 v120, 16, v248
    v_and_b32 v121, 0xffff0000, v248
    v_lshlrev_b32 v122, 16, v249
    v_and_b32 v123, 0xffff0000, v249
    v_lshlrev_b32 v124, 16, v250
    v_and_b32 v125, 0xffff0000, v250
    v_lshlrev_b32 v126, 16, v251
    v_and_b32 v127, 0xffff0000, v251
    v_lshlrev_b32 v128, 16, v252
    v_and_b32 v129, 0xffff0000, v252
    v_lshlrev_b32 v130, 16, v253
    v_and_b32 v131, 0xffff0000, v253
    v_lshlrev_b32 v132, 16, v254
    v_and_b32 v133, 0xffff0000, v254
    v_lshlrev_b32 v134, 16, v255
    v_and_b32 v135, 0xffff0000, v255
    s_lshr_b32 s72, s64, 2
    s_lshr_b32 s72, 102, s72
    s_and_b32 s72, s72, 1
    s_lshl_b32 s71, s63, 1
    s_add_u32 s71, s71, s72
    s_lshl_b32 s71, s71, 2
    s_add_u32 s71, s71, s69
    s_add_u32 s71, s71, 184
    s_lshl_b32 s74, s71, 7
    s_lshl_b32 s71, s63, 2
    s_add_u32 s71, s71, s69
    s_lshl_b32 s71, s71, 16
    s_lshl_b32 s72, s64, 7
    s_add_u32 s71, s71, s72
    s_add_u32 s75, s71, 3145728
    v_mov_b32 v136, 0
    v_mov_b32 v137, 0
    v_mov_b32 v138, 0
    v_mov_b32 v139, 0
    v_mov_b32 v140, 0
    v_mov_b32 v141, 0
    v_mov_b32 v142, 0
    v_mov_b32 v143, 0
    v_mov_b32 v144, 0
    v_mov_b32 v145, 0
    v_mov_b32 v146, 0
    v_mov_b32 v147, 0
    v_mov_b32 v148, 0
    v_mov_b32 v149, 0
    v_mov_b32 v150, 0
    v_mov_b32 v151, 0
    s_lshl_b32 m0, s69, 11
    s_mov_b32 s73, 0
L_sp_42:
    s_load_dword s71, s[58:59], s74 glc
    s_add_u32 s73, s73, 1
    s_waitcnt lgkmcnt(0)
    s_cmp_gt_u32 s73, 1000000
    s_cbranch_scc1 L_spo_43
    s_cmp_ge_u32 s71, 16
    s_cbranch_scc1 L_spo_43
    s_sleep 2
    s_branch L_sp_42
L_spo_43:
    buffer_load_dwordx4 v56, s[16:19], s75 offen sc1 lds
    buffer_load_dwordx4 v57, s[16:19], s75 offen offset:1024 sc1 lds
    s_waitcnt vmcnt(0)
    ds_read_u16_d16_hi v136, v70 offset:0
    ds_read_u16_d16_hi v137, v70 offset:128
    ds_read_u16_d16_hi v138, v70 offset:256
    ds_read_u16_d16_hi v139, v70 offset:384
    ds_read_u16_d16_hi v140, v70 offset:512
    ds_read_u16_d16_hi v141, v70 offset:640
    ds_read_u16_d16_hi v142, v70 offset:768
    ds_read_u16_d16_hi v143, v70 offset:896
    ds_read_u16_d16_hi v144, v71 offset:0
    ds_read_u16_d16_hi v145, v71 offset:128
    ds_read_u16_d16_hi v146, v71 offset:256
    ds_read_u16_d16_hi v147, v71 offset:384
    ds_read_u16_d16_hi v148, v71 offset:512
    ds_read_u16_d16_hi v149, v71 offset:640
    ds_read_u16_d16_hi v150, v71 offset:768
    ds_read_u16_d16_hi v151, v71 offset:896
    s_mov_b32 s74, 0xbfb8aa3b
    s_movk_i32 s50, 0x3f80
    s_mov_b32 s51, 0x3f800000
    s_mov_b32 s73, 0
L_spin_44:
    ds_read_b32 v50, v34 offset:0
    s_add_u32 s73, s73, 1
    s_waitcnt lgkmcnt(0)
    v_readfirstlane_b32 s71, v50
    s_cmp_gt_u32 s73, 30000000
    s_cbranch_scc1 L_spun_45
    s_cmp_lt_u32 s71, 4
    s_cbranch_scc1 L_spin_44
L_spun_45:
    ds_read_b128 v[160:163], v68 offset:0
    ds_read_b128 v[164:167], v69 offset:0
    ds_read_b128 v[168:171], v68 offset:4096
    ds_read_b128 v[172:175], v69 offset:4096
    ds_read_b128 v[176:179], v68 offset:8192
    ds_read_b128 v[180:183], v69 offset:8192
    ds_read_b128 v[184:187], v68 offset:12288
    ds_read_b128 v[188:191], v69 offset:12288
    s_waitcnt lgkmcnt(4)
    v_pk_add_f32 v[160:161], v[160:161], v[168:169]
    v_pk_add_f32 v[162:163], v[162:163], v[170:171]
    v_pk_add_f32 v[164:165], v[164:165], v[172:173]
    v_pk_add_f32 v[166:167], v[166:167], v[174:175]
    s_waitcnt lgkmcnt(0)
    v_pk_add_f32 v[176:177], v[176:177], v[184:185]
    v_pk_add_f32 v[178:179], v[178:179], v[186:187]
    v_pk_add_f32 v[180:181], v[180:181], v[188:189]
    v_pk_add_f32 v[182:183], v[182:183], v[190:191]
    v_pk_add_f32 v[160:161], v[160:161], v[176:177]
    v_pk_add_f32 v[162:163], v[162:163], v[178:179]
    v_pk_add_f32 v[164:165], v[164:165], v[180:181]
    v_pk_add_f32 v[166:167], v[166:167], v[182:183]
    v_pk_mul_f32 v[224:225], v[160:161], s[74:75] op_sel_hi:[1,0]
    v_pk_mul_f32 v[226:227], v[162:163], s[74:75] op_sel_hi:[1,0]
    v_pk_mul_f32 v[228:229], v[164:165], s[74:75] op_sel_hi:[1,0]
    v_pk_mul_f32 v[230:231], v[166:167], s[74:75] op_sel_hi:[1,0]
    v_exp_f32 v224, v224
    v_exp_f32 v225, v225
    v_exp_f32 v226, v226
    v_exp_f32 v227, v227
    v_exp_f32 v228, v228
    v_exp_f32 v229, v229
    v_exp_f32 v230, v230
    v_exp_f32 v231, v231
    v_pk_mul_f32 v[160:161], v[160:161], v[136:137]
    v_pk_mul_f32 v[162:163], v[162:163], v[138:139]
    v_pk_mul_f32 v[164:165], v[164:165], v[140:141]
    v_pk_mul_f32 v[166:167], v[166:167], v[142:143]
    v_pk_add_f32 v[224:225], v[224:225], 1.0 op_sel_hi:[1,0]
    v_pk_add_f32 v[226:227], v[226:227], 1.0 op_sel_hi:[1,0]
    v_pk_add_f32 v[228:229], v[228:229], 1.0 op_sel_hi:[1,0]
    v_pk_add_f32 v[230:231], v[230:231], 1.0 op_sel_hi:[1,0]
    v_rcp_f32 v224, v224
    v_rcp_f32 v225, v225
    v_rcp_f32 v226, v226
    v_rcp_f32 v227, v227
    v_rcp_f32 v228, v228
    v_rcp_f32 v229, v229
    v_rcp_f32 v230, v230
    v_rcp_f32 v231, v231
    v_pk_fma_f32 v[160:161], v[160:161], v[224:225], v[120:121]
    v_pk_fma_f32 v[162:163], v[162:163], v[226:227], v[122:123]
    v_pk_fma_f32 v[164:165], v[164:165], v[228:229], v[124:125]
    v_pk_fma_f32 v[166:167], v[166:167], v[230:231], v[126:127]
    v_cvt_pk_bf16_f32 v168, v160, v161
    v_cvt_pk_bf16_f32 v169, v162, v163
    v_cvt_pk_bf16_f32 v170, v164, v165
    v_cvt_pk_bf16_f32 v171, v166, v167
    buffer_store_dwordx4 v[168:171], v64, s[24:27], s41 offen
    s_barrier
    ds_read_b128 v[192:195], v68 offset:32768
    ds_read_b128 v[196:199], v69 offset:32768
    ds_read_b128 v[200:203], v68 offset:36864
    ds_read_b128 v[204:207], v69 offset:36864
    ds_read_b128 v[208:211], v68 offset:40960
    ds_read_b128 v[212:215], v69 offset:40960
    ds_read_b128 v[216:219], v68 offset:45056
    ds_read_b128 v[220:223], v69 offset:45056
    s_waitcnt lgkmcnt(4)
    v_pk_add_f32 v[192:193], v[192:193], v[200:201]
    v_pk_add_f32 v[194:195], v[194:195], v[202:203]
    v_pk_add_f32 v[196:197], v[196:197], v[204:205]
    v_pk_add_f32 v[198:199], v[198:199], v[206:207]
    s_waitcnt lgkmcnt(0)
    v_pk_add_f32 v[208:209], v[208:209], v[216:217]
    v_pk_add_f32 v[210:211], v[210:211], v[218:219]
    v_pk_add_f32 v[212:213], v[212:213], v[220:221]
    v_pk_add_f32 v[214:215], v[214:215], v[222:223]
    v_pk_add_f32 v[192:193], v[192:193], v[208:209]
    v_pk_add_f32 v[194:195], v[194:195], v[210:211]
    v_pk_add_f32 v[196:197], v[196:197], v[212:213]
    v_pk_add_f32 v[198:199], v[198:199], v[214:215]
    v_pk_mul_f32 v[224:225], v[192:193], s[74:75] op_sel_hi:[1,0]
    v_pk_mul_f32 v[226:227], v[194:195], s[74:75] op_sel_hi:[1,0]
    v_pk_mul_f32 v[228:229], v[196:197], s[74:75] op_sel_hi:[1,0]
    v_pk_mul_f32 v[230:231], v[198:199], s[74:75] op_sel_hi:[1,0]
    v_exp_f32 v224, v224
    v_exp_f32 v225, v225
    v_exp_f32 v226, v226
    v_exp_f32 v227, v227
    v_exp_f32 v228, v228
    v_exp_f32 v229, v229
    v_exp_f32 v230, v230
    v_exp_f32 v231, v231
    v_pk_mul_f32 v[192:193], v[192:193], v[144:145]
    v_pk_mul_f32 v[194:195], v[194:195], v[146:147]
    v_pk_mul_f32 v[196:197], v[196:197], v[148:149]
    v_pk_mul_f32 v[198:199], v[198:199], v[150:151]
    v_pk_add_f32 v[224:225], v[224:225], 1.0 op_sel_hi:[1,0]
    v_pk_add_f32 v[226:227], v[226:227], 1.0 op_sel_hi:[1,0]
    v_pk_add_f32 v[228:229], v[228:229], 1.0 op_sel_hi:[1,0]
    v_pk_add_f32 v[230:231], v[230:231], 1.0 op_sel_hi:[1,0]
    v_rcp_f32 v224, v224
    v_rcp_f32 v225, v225
    v_rcp_f32 v226, v226
    v_rcp_f32 v227, v227
    v_rcp_f32 v228, v228
    v_rcp_f32 v229, v229
    v_rcp_f32 v230, v230
    v_rcp_f32 v231, v231
    v_pk_fma_f32 v[192:193], v[192:193], v[224:225], v[128:129]
    v_pk_fma_f32 v[194:195], v[194:195], v[226:227], v[130:131]
    v_pk_fma_f32 v[196:197], v[196:197], v[228:229], v[132:133]
    v_pk_fma_f32 v[198:199], v[198:199], v[230:231], v[134:135]
    v_cvt_pk_bf16_f32 v200, v192, v193
    v_cvt_pk_bf16_f32 v201, v194, v195
    v_cvt_pk_bf16_f32 v202, v196, v197
    v_cvt_pk_bf16_f32 v203, v198, v199
    buffer_store_dwordx4 v[200:203], v64, s[24:27], s66 offen
    s_endpgm
L_helper:
    v_lshrrev_b32 v1, 6, v0
    v_and_b32 v0, 63, v0
    v_readfirstlane_b32 s3, v1
    s_and_b32 s60, s2, 7
    s_lshl_b32 s62, s60, 2
    s_add_u32 s62, s62, s61
    s_lshr_b32 s63, s60, 1
    s_lshl_b32 s63, s63, 2
    s_add_u32 s63, s63, s61
    s_and_b32 s64, s60, 1
    s_mul_i32 s64, s64, 14
    s_add_u32 s64, s64, s63
    s_lshl_b32 s71, s62, 3
    s_add_u32 s71, s71, s3
    s_mul_i32 s65, s71, 7168
    v_lshrrev_b32 v1, 3, v0
    v_and_b32 v2, 7, v0
    v_mul_u32_u24 v3, 896, v1
    v_lshl_add_u32 v3, v2, 4, v3
    v_lshlrev_b32 v4, 4, v0
    v_and_b32 v5, 1, v0
    v_lshlrev_b32 v5, 12, v5
    v_lshrrev_b32 v6, 1, v0
    v_lshl_add_u32 v5, v6, 4, v5
    v_mul_u32_u24 v15, 3584, v1
    v_lshl_add_u32 v15, v2, 4, v15
    s_lshl_b32 s67, s62, 7
    s_add_u32 s67, s67, 32768
    s_lshl_b32 s69, s64, 9
    s_add_u32 s69, s69, 40960
    s_mul_i32 s70, s3, 200704
    s_lshl_b32 s74, s64, 7
    s_add_u32 s70, s70, s74
    s_mov_b32 s22, 256
    s_mov_b32 s23, 0x20000
    s_mov_b32 s18, 33554432
    s_mov_b32 s19, 0x20000
    s_mov_b32 s6, 1835008
    s_mov_b32 s7, 0x20000
    s_mov_b32 s10, 1605632
    s_mov_b32 s11, 0x20000
    s_mov_b32 s14, 1605632
    s_mov_b32 s15, 0x20000
    s_mov_b32 s26, 3584
    s_mov_b32 s27, 0x20000
    s_waitcnt lgkmcnt(0)
    s_mov_b64 s[8:9], s[48:49]
    s_mov_b64 s[4:5], s[28:29]
    s_mov_b64 s[16:17], s[58:59]
    s_mov_b64 s[20:21], s[56:57]
    s_mov_b64 s[12:13], s[52:53]
    s_mov_b64 s[24:25], s[50:51]
    s_cmp_lt_u32 s63, 14
    s_cbranch_scc1 L_h0_46
    v_mov_b32 v8, 0
    v_mov_b32 v9, 0
    v_mov_b32 v10, 0
    v_mov_b32 v11, 0
    s_and_b32 s66, s60, 1
    s_lshl_b32 s66, s66, 1
    s_and_b32 s71, s61, 1
    s_add_u32 s66, s66, s71
    s_lshl_b32 s66, s66, 3
    s_add_u32 s66, s66, s3
    s_lshl_b32 s66, s66, 12
    buffer_store_dwordx4 v[8:11], v4, s[16:19], s66 offen offset:0 sc1
    buffer_store_dwordx4 v[8:11], v4, s[16:19], s66 offen offset:1024 sc1
    buffer_store_dwordx4 v[8:11], v4, s[16:19], s66 offen offset:2048 sc1
    buffer_store_dwordx4 v[8:11], v4, s[16:19], s66 offen offset:3072 sc1
    s_mov_b32 s69, 33554432
    s_mov_b32 s70, 33554432
    s_waitcnt vmcnt(0)
    s_barrier
    s_cmp_lg_u32 s3, 7
    s_cbranch_scc1 L_h0_46
    s_mov_b32 s75, 1
    s_atomic_add s75, s[56:57], 0
L_h0_46:
    buffer_load_dwordx4 v[16:19], v3, s[4:7], s65 offen offset:0
    buffer_load_dwordx4 v[20:23], v3, s[4:7], s65 offen offset:128
    buffer_load_dwordx4 v[24:27], v3, s[4:7], s65 offen offset:256
    buffer_load_dwordx4 v[28:31], v3, s[4:7], s65 offen offset:384
    buffer_load_dwordx4 v[32:35], v3, s[4:7], s65 offen offset:512
    buffer_load_dwordx4 v[36:39], v3, s[4:7], s65 offen offset:640
    buffer_load_dwordx4 v[40:43], v3, s[4:7], s65 offen offset:768
    s_barrier
    s_add_u32 s76, s70, 0
    buffer_load_dwordx4 v[44:47], v15, s[8:11], s76 offen
    s_add_u32 s76, s70, 28672
    buffer_load_dwordx4 v[48:51], v15, s[8:11], s76 offen
    s_add_u32 s76, s70, 57344
    buffer_load_dwordx4 v[52:55], v15, s[8:11], s76 offen
    s_add_u32 s76, s70, 86016
    buffer_load_dwordx4 v[56:59], v15, s[8:11], s76 offen
    s_add_u32 s76, s70, 114688
    buffer_load_dwordx4 v[60:63], v15, s[8:11], s76 offen
    s_add_u32 s76, s70, 143360
    buffer_load_dwordx4 v[64:67], v15, s[8:11], s76 offen
    s_add_u32 s76, s70, 172032
    buffer_load_dwordx4 v[68:71], v15, s[8:11], s76 offen
    v_lshlrev_b32 v6, 1, v0
    buffer_load_ushort v81, v6, s[24:27], s74 offen
    v_and_b32 v12, 1, v0
    v_lshlrev_b32 v12, 4, v12
    v_mov_b32 v13, 0xbf80
    v_lshlrev_b32 v13, v12, v13
    v_bfe_u32 v12, v0, 1, 2
    v_cmp_eq_u32 vcc, 0, v12
    s_nop 1
    v_cndmask_b32 v72, 0, v13, vcc
    v_cmp_eq_u32 vcc, 1, v12
    s_nop 1
    v_cndmask_b32 v73, 0, v13, vcc
    v_cmp_eq_u32 vcc, 2, v12
    s_nop 1
    v_cndmask_b32 v74, 0, v13, vcc
    v_cmp_eq_u32 vcc, 3, v12
    s_nop 1
    v_cndmask_b32 v75, 0, v13, vcc
    v_lshrrev_b32 v82, 5, v0
    v_lshl_add_u32 v82, s3, 1, v82
    v_lshlrev_b32 v82, 8, v82
    v_bfe_u32 v13, v0, 4, 1
    v_lshl_add_u32 v82, v13, 7, v82
    v_lshl_add_u32 v82, v2, 2, v82
    v_add_u32 v82, 1024, v82
    v_mov_b32 v12, 0
    v_mov_b32 v13, 0
    s_mov_b32 s68, 0x3f803f80
    buffer_load_dword v83, off, s[20:23], 0 sc1
    s_waitcnt vmcnt(15)
    v_dot2c_f32_bf16 v12, s68, v16
    v_dot2c_f32_bf16 v13, v16, v16
    v_dot2c_f32_bf16 v12, s68, v17
    v_dot2c_f32_bf16 v13, v17, v17
    v_dot2c_f32_bf16 v12, s68, v18
    v_dot2c_f32_bf16 v13, v18, v18
    v_dot2c_f32_bf16 v12, s68, v19
    v_dot2c_f32_bf16 v13, v19, v19
    s_waitcnt vmcnt(14)
    v_dot2c_f32_bf16 v12, s68, v20
    v_dot2c_f32_bf16 v13, v20, v20
    v_dot2c_f32_bf16 v12, s68, v21
    v_dot2c_f32_bf16 v13, v21, v21
    v_dot2c_f32_bf16 v12, s68, v22
    v_dot2c_f32_bf16 v13, v22, v22
    v_dot2c_f32_bf16 v12, s68, v23
    v_dot2c_f32_bf16 v13, v23, v23
    s_waitcnt vmcnt(13)
    v_dot2c_f32_bf16 v12, s68, v24
    v_dot2c_f32_bf16 v13, v24, v24
    v_dot2c_f32_bf16 v12, s68, v25
    v_dot2c_f32_bf16 v13, v25, v25
    v_dot2c_f32_bf16 v12, s68, v26
    v_dot2c_f32_bf16 v13, v26, v26
    v_dot2c_f32_bf16 v12, s68, v27
    v_dot2c_f32_bf16 v13, v27, v27
    s_waitcnt vmcnt(12)
    v_dot2c_f32_bf16 v12, s68, v28
    v_dot2c_f32_bf16 v13, v28, v28
    v_dot2c_f32_bf16 v12, s68, v29
    v_dot2c_f32_bf16 v13, v29, v29
    v_dot2c_f32_bf16 v12, s68, v30
    v_dot2c_f32_bf16 v13, v30, v30
    v_dot2c_f32_bf16 v12, s68, v31
    v_dot2c_f32_bf16 v13, v31, v31
    s_waitcnt vmcnt(11)
    v_dot2c_f32_bf16 v12, s68, v32
    v_dot2c_f32_bf16 v13, v32, v32
    v_dot2c_f32_bf16 v12, s68, v33
    v_dot2c_f32_bf16 v13, v33, v33
    v_dot2c_f32_bf16 v12, s68, v34
    v_dot2c_f32_bf16 v13, v34, v34
    v_dot2c_f32_bf16 v12, s68, v35
    v_dot2c_f32_bf16 v13, v35, v35
    s_waitcnt vmcnt(10)
    v_dot2c_f32_bf16 v12, s68, v36
    v_dot2c_f32_bf16 v13, v36, v36
    v_dot2c_f32_bf16 v12, s68, v37
    v_dot2c_f32_bf16 v13, v37, v37
    v_dot2c_f32_bf16 v12, s68, v38
    v_dot2c_f32_bf16 v13, v38, v38
    v_dot2c_f32_bf16 v12, s68, v39
    v_dot2c_f32_bf16 v13, v39, v39
    s_waitcnt vmcnt(9)
    v_dot2c_f32_bf16 v12, s68, v40
    v_dot2c_f32_bf16 v13, v40, v40
    v_dot2c_f32_bf16 v12, s68, v41
    v_dot2c_f32_bf16 v13, v41, v41
    v_dot2c_f32_bf16 v12, s68, v42
    v_dot2c_f32_bf16 v13, v42, v42
    v_dot2c_f32_bf16 v12, s68, v43
    v_dot2c_f32_bf16 v13, v43, v43
    s_nop 1
    v_add_f32_dpp v12, v12, v12 quad_perm:[1,0,3,2] row_mask:0xf bank_mask:0xf
    v_add_f32_dpp v13, v13, v13 quad_perm:[1,0,3,2] row_mask:0xf bank_mask:0xf
    s_nop 0
    v_add_f32_dpp v12, v12, v12 quad_perm:[2,3,0,1] row_mask:0xf bank_mask:0xf
    v_add_f32_dpp v13, v13, v13 quad_perm:[2,3,0,1] row_mask:0xf bank_mask:0xf
    s_nop 0
    v_add_f32_dpp v12, v12, v12 row_half_mirror row_mask:0xf bank_mask:0xf
    v_add_f32_dpp v13, v13, v13 row_half_mirror row_mask:0xf bank_mask:0xf
    v_mul_f32 v12, 0x3b124925, v12
    v_mul_f32 v13, 0x3b124925, v13
    v_fma_f32 v13, -v12, v12, v13
    v_max_f32 v13, 0, v13
    v_cvt_pk_bf16_f32 v13, v13, v13
    v_and_b32 v13, 0xffff0000, v13
    v_add_f32 v13, 0x3727c5ac, v13
    v_cvt_pk_bf16_f32 v13, v13, v13
    v_and_b32 v13, 0xffff0000, v13
    v_sqrt_f32 v13, v13
    v_lshl_add_u32 v14, s3, 3, v1
    v_lshlrev_b32 v14, 2, v14
    v_cvt_pk_bf16_f32 v12, v12, v13
    ds_write_b32 v14, v12
    s_waitcnt vmcnt(8)
    v_mfma_f32_16x16x32_bf16 v[76:79], v[44:47], v[72:75], 0
    s_waitcnt vmcnt(7)
    v_mfma_f32_16x16x32_bf16 v[76:79], v[48:51], v[72:75], v[76:79]
    s_waitcnt vmcnt(6)
    v_mfma_f32_16x16x32_bf16 v[76:79], v[52:55], v[72:75], v[76:79]
    s_waitcnt vmcnt(5)
    v_mfma_f32_16x16x32_bf16 v[76:79], v[56:59], v[72:75], v[76:79]
    s_waitcnt vmcnt(4)
    v_mfma_f32_16x16x32_bf16 v[76:79], v[60:63], v[72:75], v[76:79]
    s_waitcnt vmcnt(3)
    v_mfma_f32_16x16x32_bf16 v[76:79], v[64:67], v[72:75], v[76:79]
    s_waitcnt vmcnt(2)
    v_mfma_f32_16x16x32_bf16 v[76:79], v[68:71], v[72:75], v[76:79]
    s_nop 7
    ds_write2_b32 v82, v76, v77 offset0:0 offset1:8
    ds_write2_b32 v82, v78, v79 offset0:16 offset1:24
    s_mov_b32 s73, 0
    s_waitcnt vmcnt(0)
L_vp_47:
    v_cmp_gt_u32 vcc, 4, v83
    s_add_u32 s73, s73, 1
    s_cmp_gt_u32 s73, 1000000
    s_cbranch_scc1 L_vpo_48
    s_cbranch_vccz L_vpo_48
    s_sleep 2
    buffer_load_dword v83, off, s[20:23], 0 sc1
    s_waitcnt vmcnt(0)
    s_branch L_vp_47
L_vpo_48:
    s_waitcnt lgkmcnt(0)
    s_barrier
    s_cmp_lg_u32 s3, 0
    s_cbranch_scc1 L_h2_49
    s_mov_b64 exec, 0xffff
    ds_read_b128 v[8:11], v4
    s_waitcnt lgkmcnt(0)
    buffer_store_dwordx4 v[8:11], v5, s[16:19], s67 offen sc1
    s_mov_b64 exec, -1
L_h2_49:
    s_cmp_lg_u32 s3, 1
    s_cbranch_scc1 L_h3_50
    v_lshlrev_b32 v12, 2, v0
    ds_read2st64_b32 v[16:17], v12 offset0:4 offset1:5
    ds_read2st64_b32 v[18:19], v12 offset0:6 offset1:7
    ds_read2st64_b32 v[20:21], v12 offset0:8 offset1:9
    ds_read2st64_b32 v[22:23], v12 offset0:10 offset1:11
    ds_read2st64_b32 v[24:25], v12 offset0:12 offset1:13
    ds_read2st64_b32 v[26:27], v12 offset0:14 offset1:15
    ds_read2st64_b32 v[28:29], v12 offset0:16 offset1:17
    ds_read2st64_b32 v[30:31], v12 offset0:18 offset1:19
    s_waitcnt lgkmcnt(0)
    v_add_f32 v16, v16, v17
    v_add_f32 v18, v18, v19
    v_add_f32 v20, v20, v21
    v_add_f32 v22, v22, v23
    v_add_f32 v24, v24, v25
    v_add_f32 v26, v26, v27
    v_add_f32 v28, v28, v29
    v_add_f32 v30, v30, v31
    v_add_f32 v16, v16, v18
    v_add_f32 v20, v20, v22
    v_add_f32 v24, v24, v26
    v_add_f32 v28, v28, v30
    v_add_f32 v16, v16, v20
    v_add_f32 v24, v24, v28
    v_add_f32 v16, v16, v24
    v_cvt_pk_bf16_f32 v12, v16, v16
    v_and_b32 v12, 0xffff0000, v12
    v_sub_f32 v12, v16, v12
    v_cvt_pk_bf16_f32 v80, v16, v12
    v_or_b32 v81, 0x10000, v81
    v_lshlrev_b32 v12, 3, v0
    buffer_store_dwordx2 v[80:81], v12, s[16:19], s69 offen sc1
L_h3_50:
    s_barrier
    v_lshlrev_b32 v14, 7, v0
    s_mul_i32 s76, s61, 401408
    s_mul_i32 s77, s60, 49
    s_lshr_b32 s77, s77, 3
    s_add_u32 s77, s77, s3
    s_sub_u32 s71, s77, 49
    s_cmp_ge_u32 s77, 49
    s_cselect_b32 s77, s71, s77
    s_lshl_b32 s71, s77, 13
    s_add_u32 s71, s71, s76
    s_add_u32 s77, s77, 8
    buffer_load_dword v90, v14, s[12:15], s71 offen
    s_waitcnt vmcnt(0)
L_end:
    s_endpgm
.p2align 7
.type L_tab,@object
.size L_tab, 4096
L_tab:
.short 2128, 2128, 2120, 2120, 2120, 2116, 2116, 2116
.short 2116, 2116, 2112, 2112, 2112, 2108, 2108, 2108
.short 2108, 2108, 2104, 2104, 2104, 2100, 2100, 2100
.short 2100, 2100, 2096, 2096, 2096, 2092, 2092, 2092
.short 2092, 2092, 2088, 2088, 2088, 2084, 2084, 2084
.short 2084, 2084, 2080, 2080, 2080, 2076, 2076, 2076
.short 2076, 2076, 2072, 2072, 2072, 2068, 2068, 2068
.short 2068, 2068, 2064, 2064, 2064, 2060, 2060, 2060
.short 2060, 2060, 2056, 2056, 2056, 2052, 2052, 2052
.short 2052, 2052, 2048, 2048, 2048, 2044, 2044, 2044
.short 2044, 2044, 2040, 2040, 2040, 2036, 2036, 2036
.short 2036, 2036, 2032, 2032, 2032, 2028, 2028, 2028
.short 2028, 2028, 2024, 2024, 2024, 2020, 2020, 2020
.short 2020, 2020, 2016, 2016, 2016, 2012, 2012, 2012
.short 2012, 2012, 2008, 2008, 2008, 2004, 2004, 2004
.short 2004, 2004, 2000, 2000, 2000, 1996, 1996, 1996
.short 1996, 1996, 1988, 1988, 1988, 1984, 1984, 1984
.short 1984, 1984, 1980, 1980, 1980, 1976, 1976, 1976
.short 1976, 1976, 1972, 1972, 1972, 1968, 1968, 1968
.short 1968, 1968, 1964, 1964, 1964, 1960, 1960, 1960
.short 1960, 1960, 1956, 1956, 1956, 1952, 1952, 1952
.short 1952, 1952, 1948, 1948, 1948, 1944, 1944, 1944
.short 1944, 1944, 1940, 1940, 1940, 1936, 1936, 1936
.short 1936, 1936, 1932, 1932, 1932, 1928, 1928, 1928
.short 1928, 1928, 1924, 1924, 1924, 1920, 1920, 1920
.short 1920, 1920, 1916, 1916, 1916, 1912, 1912, 1912
.short 1912, 1912, 1908, 1908, 1908, 1904, 1904, 1904
.short 1904, 1904, 1900, 1900, 1900, 1896, 1896, 1896
.short 1896, 1896, 1892, 1892, 1892, 1888, 1888, 1888
.short 1888, 1888, 1884, 1884, 1884, 1880, 1880, 1880
.short 1880, 1880, 1876, 1876, 1876, 1872, 1872, 1872
.short 1872, 1872, 1868, 1868, 1868, 1864, 1864, 1864
.short 1864, 1864, 1856, 1856, 1856, 1852, 1852, 1852
.short 1852, 1852, 1848, 1848, 1848, 1844, 1844, 1844
.short 1844, 1844, 1840, 1840, 1840, 1836, 1836, 1836
.short 1836, 1836, 1832, 1832, 1832, 1828, 1828, 1828
.short 1828, 1828, 1824, 1824, 1824, 1820, 1820, 1820
.short 1820, 1820, 1816, 1816, 1816, 1812, 1812, 1812
.short 1812, 1812, 1808, 1808, 1808, 1804, 1804, 1804
.short 1804, 1804, 1800, 1800, 1800, 1796, 1796, 1796
.short 1796, 1796, 1792, 1792, 1792, 1788, 1788, 1788
.short 1788, 1788, 1784, 1784, 1784, 1780, 1780, 1780
.short 1780, 1780, 1776, 1776, 1776, 1772, 1772, 1772
.short 1772, 1772, 1768, 1768, 1768, 1764, 1764, 1764
.short 1764, 1764, 1760, 1760, 1760, 1756, 1756, 1756
.short 1756, 1756, 1752, 1752, 1752, 1748, 1748, 1748
.short 1748, 1748, 1744, 1744, 1744, 1740, 1740, 1740
.short 1740, 1740, 1736, 1736, 1736, 1732, 1732, 1732
.short 1732, 1732, 1724, 1724, 1724, 1720, 1720, 1720
.short 1720, 1720, 1716, 1716, 1716, 1712, 1712, 1712
.short 1712, 1712, 1708, 1708, 1708, 1704, 1704, 1704
.short 1704, 1704, 1700, 1700, 1700, 1696, 1696, 1696
.short 1696, 1696, 1692, 1692, 1692, 1688, 1688, 1688
.short 1688, 1688, 1684, 1684, 1684, 1680, 1680, 1680
.short 1680, 1680, 1676, 1676, 1676, 1672, 1672, 1672
.short 1672, 1672, 1668, 1668, 1668, 1664, 1664, 1664
.short 1664, 1664, 1660, 1660, 1660, 1656, 1656, 1656
.short 1656, 1656, 1652, 1652, 1652, 1648, 1648, 1648
.short 1648, 1648, 1644, 1644, 1644, 1640, 1640, 1640
.short 1640, 1640, 1636, 1636, 1636, 1632, 1632, 1632
.short 1632, 1632, 1628, 1628, 1628, 1624, 1624, 1624
.short 1624, 1624, 1620, 1620, 1620, 1616, 1616, 1616
.short 1616, 1616, 1612, 1612, 1612, 1608, 1608, 1608
.short 1608, 1608, 1604, 1604, 1604, 1600, 1600, 1600
.short 2116, 2116, 2112, 2648, 2656, 2648, 12760, 256
.short 2108, 2108, 2104, 2644, 2648, 2644, 8600, 288
.short 2100, 2100, 2096, 2640, 2644, 2640, 4440, 320
.short 2092, 2092, 2088, 2636, 2640, 2636, 280, 352
.short 2084, 2084, 2080, 2632, 2636, 2632, 12752, 384
.short 2076, 2076, 2072, 2628, 2632, 2628, 8592, 416
.short 2068, 2068, 2064, 2624, 2628, 2624, 4432, 448
.short 2060, 2060, 2056, 2620, 2624, 2620, 272, 480
.short 2052, 2052, 2048, 2616, 2620, 2616, 12744, 512
.short 2044, 2044, 2040, 2612, 2616, 2612, 8584, 544
.short 2036, 2036, 2032, 2608, 2612, 2608, 4424, 576
.short 2028, 2028, 2024, 2604, 2608, 2604, 264, 608
.short 2020, 2020, 2016, 2600, 2604, 2600, 12736, 640
.short 2012, 2012, 2008, 2596, 2600, 2596, 8576, 672
.short 2004, 2004, 2000, 2592, 2596, 2592, 4416, 704
.short 1996, 1996, 1988, 2588, 2592, 2588, 256, 736
.short 1984, 1984, 1980, 2584, 2588, 2584, 12776, 272
.short 1976, 1976, 1972, 2580, 2584, 2580, 8616, 304
.short 1968, 1968, 1964, 2576, 2580, 2576, 4456, 336
.short 1960, 1960, 1956, 2572, 2576, 2572, 296, 368
.short 1952, 1952, 1948, 2568, 2572, 2568, 12768, 400
.short 1944, 1944, 1940, 2564, 2568, 2564, 8608, 432
.short 1936, 1936, 1932, 2560, 2564, 2560, 4448, 464
.short 1928, 1928, 1924, 2556, 2560, 2556, 288, 496
.short 1920, 1920, 1916, 2552, 2556, 2552, 12760, 528
.short 1912, 1912, 1908, 2548, 2552, 2548, 8600, 560
.short 1904, 1904, 1900, 2544, 2548, 2544, 4440, 592
.short 1896, 1896, 1892, 2540, 2544, 2540, 280, 624
.short 1888, 1888, 1884, 2536, 2540, 2536, 12752, 656
.short 1880, 1880, 1876, 2532, 2536, 2532, 8592, 688
.short 1872, 1872, 1868, 2528, 2532, 2528, 4432, 720
.short 1864, 1864, 1856, 2524, 2528, 2524, 272, 752
.short 1852, 1852, 1848, 2516, 2524, 2516, 12792, 288
.short 1844, 1844, 1840, 2512, 2516, 2512, 8632, 320
.short 1836, 1836, 1832, 2508, 2512, 2508, 4472, 352
.short 1828, 1828, 1824, 2504, 2508, 2504, 312, 384
.short 1820, 1820, 1816, 2500, 2504, 2500, 12784, 416
.short 1812, 1812, 1808, 2496, 2500, 2496, 8624, 448
.short 1804, 1804, 1800, 2492, 2496, 2492, 4464, 480
.short 1796, 1796, 1792, 2488, 2492, 2488, 304, 512
.short 1788, 1788, 1784, 2484, 2488, 2484, 12776, 544
.short 1780, 1780, 1776, 2480, 2484, 2480, 8616, 576
.short 1772, 1772, 1768, 2476, 2480, 2476, 4456, 608
.short 1764, 1764, 1760, 2472, 2476, 2472, 296, 640
.short 1756, 1756, 1752, 2468, 2472, 2468, 12768, 672
.short 1748, 1748, 1744, 2464, 2468, 2464, 8608, 704
.short 1740, 1740, 1736, 2460, 2464, 2460, 4448, 736
.short 1732, 1732, 1724, 2456, 2460, 2456, 288, 768
.short 1720, 1720, 1716, 2452, 2456, 2452, 12808, 304
.short 1712, 1712, 1708, 2448, 2452, 2448, 8648, 336
.short 1704, 1704, 1700, 2444, 2448, 2444, 4488, 368
.short 1696, 1696, 1692, 2440, 2444, 2440, 328, 400
.short 1688, 1688, 1684, 2436, 2440, 2436, 12800, 432
.short 1680, 1680, 1676, 2432, 2436, 2432, 8640, 464
.short 1672, 1672, 1668, 2428, 2432, 2428, 4480, 496
.short 1664, 1664, 1660, 2424, 2428, 2424, 320, 528
.short 1656, 1656, 1652, 2420, 2424, 2420, 12792, 560
.short 1648, 1648, 1644, 2416, 2420, 2416, 8632, 592
.short 1640, 1640, 1636, 2412, 2416, 2412, 4472, 624
.short 1632, 1632, 1628, 2408, 2412, 2408, 312, 656
.short 1624, 1624, 1620, 2404, 2408, 2404, 12784, 688
.short 1616, 1616, 1612, 2400, 2404, 2400, 8624, 720
.short 1608, 1608, 1604, 2396, 2400, 2396, 4464, 752
.short 1600, 1592, 1588, 2392, 2396, 2392, 304, 784
.short 1600, 1592, 1588, 1588, 1588, 1584, 1580, 1580
.short 1580, 1576, 1572, 1572, 1572, 1568, 1564, 1564
.short 1564, 1560, 1556, 1556, 1556, 1552, 1548, 1548
.short 1548, 1544, 1540, 1540, 1540, 1536, 1532, 1532
.short 1532, 1528, 1524, 1524, 1524, 1520, 1516, 1516
.short 1516, 1512, 1508, 1508, 1508, 1504, 1500, 1500
.short 1500, 1496, 1492, 1492, 1492, 1488, 1484, 1484
.short 1484, 1480, 1476, 1476, 1476, 1472, 1468, 1468
.short 1468, 1460, 1456, 1456, 1456, 1452, 1448, 1448
.short 1448, 1444, 1440, 1440, 1440, 1436, 1432, 1432
.short 1432, 1428, 1424, 1424, 1424, 1420, 1416, 1416
.short 1416, 1412, 1408, 1408, 1408, 1404, 1400, 1400
.short 1400, 1396, 1392, 1392, 1392, 1388, 1384, 1384
.short 1384, 1380, 1376, 1376, 1376, 1372, 1368, 1368
.short 1368, 1364, 1360, 1360, 1360, 1356, 1352, 1352
.short 1352, 1348, 1344, 1344, 1344, 1340, 1336, 1336
.short 1336, 1328, 1324, 1324, 1324, 1320, 1316, 1316
.short 1316, 1312, 1308, 1308, 1308, 1304, 1300, 1300
.short 1300, 1296, 1292, 1292, 1292, 1288, 1284, 1284
.short 1284, 1280, 1276, 1276, 1276, 1272, 1268, 1268
.short 1268, 1264, 1260, 1260, 1260, 1256, 1252, 1252
.short 1252, 1248, 1244, 1244, 1244, 1240, 1236, 1236
.short 1236, 1232, 1228, 1228, 1228, 1224, 1220, 1220
.short 1220, 1216, 1212, 1212, 1212, 1208, 1204, 1204
.short 1204, 1196, 1192, 1192, 1192, 1188, 1184, 1184
.short 1184, 1180, 1176, 1176, 1176, 1172, 1168, 1168
.short 1168, 1164, 1160, 1160, 1160, 1156, 1152, 1152
.short 1152, 1148, 1144, 1144, 1144, 1140, 1136, 1136
.short 1136, 1132, 1128, 1128, 1128, 1124, 1120, 1120
.short 1120, 1116, 1112, 1112, 1112, 1108, 1104, 1104
.short 1104, 1100, 1096, 1096, 1096, 1092, 1088, 1088
.short 1088, 1084, 1080, 1080, 1080, 1076, 1072, 1072
.short 1064, 1060, 1056, 1052, 1048, 1044, 1040, 1036
.short 1032, 1028, 1024, 1020, 1016, 1012, 1008, 1004
.short 1000, 996, 992, 988, 984, 980, 976, 972
.short 968, 964, 960, 956, 952, 948, 944, 940
.short 932, 928, 924, 920, 916, 912, 908, 904
.short 900, 896, 892, 888, 884, 880, 876, 872
.short 868, 864, 860, 856, 852, 848, 844, 840
.short 836, 832, 828, 824, 820, 816, 812, 808
.short 800, 796, 792, 788, 784, 780, 776, 772
.short 768, 764, 760, 756, 752, 748, 744, 740
.short 736, 732, 728, 724, 720, 716, 712, 708
.short 704, 700, 696, 692, 688, 684, 680, 676
.short 668, 664, 660, 656, 652, 648, 644, 640
.short 636, 632, 628, 624, 620, 616, 612, 608
.short 604, 600, 596, 592, 588, 584, 580, 576
.short 572, 568, 564, 560, 556, 552, 548, 544
.short 536, 532, 528, 524, 520, 516, 512, 508
.short 504, 500, 496, 492, 488, 484, 480, 476
.short 472, 468, 464, 460, 456, 452, 448, 444
.short 440, 436, 432, 428, 424, 420, 416, 412
.short 404, 400, 396, 392, 388, 384, 380, 376
.short 372, 368, 364, 360, 356, 352, 348, 344
.short 340, 336, 332, 328, 324, 320, 316, 312
.short 308, 304, 300, 296, 292, 288, 284, 280
.short 272, 268, 264, 260, 256, 252, 248, 244
.short 240, 236, 232, 228, 224, 220, 216, 212
.short 208, 204, 200, 196, 192, 188, 184, 180
.short 176, 172, 168, 164, 160, 156, 152, 148
.short 140, 136, 132, 128, 124, 120, 116, 112
.short 108, 104, 100, 96, 92, 88, 84, 80
.short 76, 72, 68, 64, 60, 56, 52, 48
.short 44, 40, 36, 32, 28, 24, 20, 16
.short 1580, 1576, 1572, 2384, 2392, 2384, 12504, 0
.short 1564, 1560, 1556, 2380, 2384, 2380, 8344, 32
.short 1548, 1544, 1540, 2376, 2380, 2376, 4184, 64
.short 1532, 1528, 1524, 2372, 2376, 2372, 24, 96
.short 1516, 1512, 1508, 2368, 2372, 2368, 12496, 128
.short 1500, 1496, 1492, 2364, 2368, 2364, 8336, 160
.short 1484, 1480, 1476, 2360, 2364, 2360, 4176, 192
.short 1468, 1460, 1456, 2356, 2360, 2356, 16, 224
.short 1448, 1444, 1440, 2352, 2356, 2352, 12488, 256
.short 1432, 1428, 1424, 2348, 2352, 2348, 8328, 288
.short 1416, 1412, 1408, 2344, 2348, 2344, 4168, 320
.short 1400, 1396, 1392, 2340, 2344, 2340, 8, 352
.short 1384, 1380, 1376, 2336, 2340, 2336, 12480, 384
.short 1368, 1364, 1360, 2332, 2336, 2332, 8320, 416
.short 1352, 1348, 1344, 2328, 2332, 2328, 4160, 448
.short 1336, 1328, 1324, 2324, 2328, 2324, 0, 480
.short 1316, 1312, 1308, 2320, 2324, 2320, 12520, 16
.short 1300, 1296, 1292, 2316, 2320, 2316, 8360, 48
.short 1284, 1280, 1276, 2312, 2316, 2312, 4200, 80
.short 1268, 1264, 1260, 2308, 2312, 2308, 40, 112
.short 1252, 1248, 1244, 2304, 2308, 2304, 12512, 144
.short 1236, 1232, 1228, 2300, 2304, 2300, 8352, 176
.short 1220, 1216, 1212, 2296, 2300, 2296, 4192, 208
.short 1204, 1196, 1192, 2292, 2296, 2292, 32, 240
.short 1184, 1180, 1176, 2288, 2292, 2288, 12504, 272
.short 1168, 1164, 1160, 2284, 2288, 2284, 8344, 304
.short 1152, 1148, 1144, 2280, 2284, 2280, 4184, 336
.short 1136, 1132, 1128, 2276, 2280, 2276, 24, 368
.short 1120, 1116, 1112, 2272, 2276, 2272, 12496, 400
.short 1104, 1100, 1096, 2268, 2272, 2268, 8336, 432
.short 1088, 1084, 1080, 2264, 2268, 2264, 4176, 464
.short 1064, 1060, 1056, 2260, 2264, 2260, 16, 496
.short 1032, 1028, 1024, 2252, 2260, 2252, 12536, 32
.short 1000, 996, 992, 2248, 2252, 2248, 8376, 64
.short 968, 964, 960, 2244, 2248, 2244, 4216, 96
.short 932, 928, 924, 2240, 2244, 2240, 56, 128
.short 900, 896, 892, 2236, 2240, 2236, 12528, 160
.short 868, 864, 860, 2232, 2236, 2232, 8368, 192
.short 836, 832, 828, 2228, 2232, 2228, 4208, 224
.short 800, 796, 792, 2224, 2228, 2224, 48, 256
.short 768, 764, 760, 2220, 2224, 2220, 12520, 288
.short 736, 732, 728, 2216, 2220, 2216, 8360, 320
.short 704, 700, 696, 2212, 2216, 2212, 4200, 352
.short 668, 664, 660, 2208, 2212, 2208, 40, 384
.short 636, 632, 628, 2204, 2208, 2204, 12512, 416
.short 604, 600, 596, 2200, 2204, 2200, 8352, 448
.short 572, 568, 564, 2196, 2200, 2196, 4192, 480
.short 536, 532, 528, 2192, 2196, 2192, 32, 512
.short 504, 500, 496, 2188, 2192, 2188, 12552, 48
.short 472, 468, 464, 2184, 2188, 2184, 8392, 80
.short 440, 436, 432, 2180, 2184, 2180, 4232, 112
.short 404, 400, 396, 2176, 2180, 2176, 72, 144
.short 372, 368, 364, 2172, 2176, 2172, 12544, 176
.short 340, 336, 332, 2168, 2172, 2168, 8384, 208
.short 308, 304, 300, 2164, 2168, 2164, 4224, 240
.short 272, 268, 264, 2160, 2164, 2160, 64, 272
.short 240, 236, 232, 2156, 2160, 2156, 12536, 304
.short 208, 204, 200, 2152, 2156, 2152, 8376, 336
.short 176, 172, 168, 2148, 2152, 2148, 4216, 368
.short 140, 136, 132, 2144, 2148, 2144, 56, 400
.short 108, 104, 100, 2140, 2144, 2140, 12528, 432
.short 76, 72, 68, 2136, 2140, 2136, 8368, 464
.short 44, 40, 36, 2132, 2136, 2132, 4208, 496
.short 8, 8, 8, 2128, 2132, 2120, 48, 528

.section .rodata,"a"
.p2align 6
.amdhsa_kernel recurrent_scan__ssm_conv_s4__dense_activation_mish__prompt_kernel
  .amdhsa_next_free_vgpr 256
  .amdhsa_next_free_sgpr 102
  .amdhsa_accum_offset 256
  .amdhsa_group_segment_fixed_size 0
  .amdhsa_kernarg_size 128
  .amdhsa_user_sgpr_count 2
  .amdhsa_user_sgpr_kernarg_segment_ptr 1
  .amdhsa_system_sgpr_workgroup_id_x 1
  .amdhsa_float_denorm_mode_32 3
.end_amdhsa_kernel
```
